```python
import torch

def _softmax(x, axis=-1):
    return torch.softmax(x, dim=axis)
def _gelu(x):
    return torch.nn.functional.gelu(x, approximate="tanh")
def _silu(x):
    return torch.nn.functional.silu(x)
def _sigmoid(x):
    return torch.sigmoid(x)
def _layernorm(x, axis=-1, eps=1e-5):
    m = x.mean(dim=axis, keepdim=True)
    v = x.var(dim=axis, keepdim=True, unbiased=False)
    return (x - m) / torch.sqrt(v + eps)
def _scatter_add(tgt, idx, src, axis=0):
    return tgt.clone().index_add_(axis, idx, src)
def _segment_sum(src, seg, n):
    out = torch.zeros((n,) + src.shape[1:], dtype=src.dtype)
    return out.index_add_(0, seg, src)
def _pad(x, pw):
    flat = tuple(v for pair in reversed(pw) for v in pair)
    return torch.nn.functional.pad(x, flat)

kernel_name = 'parallel_sum__sliding_block_cached__geglu_ffn__decode'

def setup_inputs():

    _w = (lambda a: (lambda t: t.to(torch.bfloat16) if t.is_floating_point() else t)(torch.as_tensor(a)))
    def _A_setup():
        B, Sq, D = 1, 1, 512
        Hq, Hkv, Sk, Dh = 32, 32, 32768, 128
        assert Hq % Hkv == 0, (Hq, Hkv)
        return {
            "x": _w((lambda *s: torch.randn(*s, dtype=torch.bfloat16) * 0.05)(B, Sq, D)),
            "k_cache": _w((lambda *s: torch.randn(*s, dtype=torch.bfloat16) * 3.2)(B, Hkv, Sk, Dh)),
            "v_cache": _w((lambda *s: torch.randn(*s, dtype=torch.bfloat16) * 1.6)(B, Hkv, Sk, Dh)),
            "wq": _w((lambda *s: torch.randn(*s, dtype=torch.bfloat16) * 3.2)(D, Hq * Dh) * (D ** -0.5)),
            "wo": _w((lambda *s: torch.randn(*s, dtype=torch.bfloat16) * 1.6)(Hq * Dh, D) * ((Hq * Dh) ** -0.5)),
        }
    _A_in = _A_setup()

    def _B_setup():
        B, S, D, F = 1, 1, 512, 1376
        return {
            "x": _w((lambda *s: torch.randn(*s, dtype=torch.bfloat16) * 0.05)(B, S, D)),
            "w_gate": _w((lambda *s: torch.randn(*s, dtype=torch.bfloat16) * 0.05)(D, F)),
            "w_up": _w((lambda *s: torch.randn(*s, dtype=torch.bfloat16) * 0.05)(D, F)),
            "w_down": _w((lambda *s: torch.randn(*s, dtype=torch.bfloat16) * 0.05)(F, D)),
        }
    _B_in = _B_setup()

    return {
        "A_x": _A_in["x"],
        "A_k_cache": _A_in["k_cache"],
        "A_v_cache": _A_in["v_cache"],
        "A_wq": _A_in["wq"],
        "A_wo": _A_in["wo"],
        "B_x": _B_in["x"],
        "B_w_gate": _B_in["w_gate"],
        "B_w_up": _B_in["w_up"],
        "B_w_down": _B_in["w_down"],
    }

def reference(A_x, A_k_cache, A_v_cache, A_wq, A_wo, B_x, B_w_gate, B_w_up, B_w_down):
    def _A_ref(x, k_cache, v_cache, wq, wo):
        B, Sq, D = x.shape
        Hq, Dh = 32, 128
        Hkv, Sk = k_cache.shape[1], k_cache.shape[2]
        W = min(4096, max(256, Sk // 4))
        rep = Hq // Hkv
        q = (lambda x, *d: x.permute(*d))((x @ wq).reshape(B, Sq, Hq, Dh), 0, 2, 1, 3)
        k = (lambda x, n, axis: torch.repeat_interleave(x, n, dim=axis))(k_cache[:, :, Sk - W:, :], rep, axis=1)
        v = (lambda x, n, axis: torch.repeat_interleave(x, n, dim=axis))(v_cache[:, :, Sk - W:, :], rep, axis=1)
        scores = torch.einsum("bhqd,bhkd->bhqk", q, k) * (Dh ** -0.5)
        p = _softmax(scores, axis=-1)
        o = torch.einsum("bhqk,bhkd->bhqd", p, v)
        return (lambda x, *d: x.permute(*d))(o, 0, 2, 1, 3).reshape(B, Sq, Hq * Dh) @ wo

    def _B_ref(x, w_gate, w_up, w_down):
        return (_gelu(x @ w_gate) * (x @ w_up)) @ w_down

    x = A_x
    xn = _layernorm(x, axis=-1)
    return x + _A_ref(xn, A_k_cache, A_v_cache, A_wq, A_wo) + _B_ref(xn, B_w_gate, B_w_up, B_w_down)
```

```asm
; @launch grid=(256,1,1) block=(640,1,1) lds=29184
.amdgcn_target "amdgcn-amd-amdhsa--gfx950"
.text
.globl parallel_sum__sliding_block_cached__geglu_ffn__decode_kernel
.p2align 8
.type parallel_sum__sliding_block_cached__geglu_ffn__decode_kernel,@function

parallel_sum__sliding_block_cached__geglu_ffn__decode_kernel:
    s_load_dwordx16 s[4:19], s[0:1], 0
    s_load_dwordx8 s[20:27], s[0:1], 64
    s_cmpk_ge_u32 s2, 256
    s_cbranch_scc1 L_end
    v_lshrrev_b32 v1, 6, v0
    v_and_b32 v0, 63, v0
    s_and_b32 s28, s2, 7
    v_readfirstlane_b32 s30, v1
    s_lshr_b32 s29, s2, 6
    s_lshl_b32 s29, s29, 3
    s_add_u32 s28, s28, s29
    s_bfe_u32 s29, s2, 0x30003
    v_lshlrev_b32 v1, 4, v0
    s_mov_b32 s35, 0x20000
    s_cmp_eq_u32 s30, 0
    s_cbranch_scc1 L_aux
    s_cmp_eq_u32 s30, 9
    s_cbranch_scc1 L_probe
    s_setprio 2
    s_lshl_b32 s40, s28, 23
    s_lshl_b32 s41, s29, 17
    s_add_u32 s40, s40, s41
    s_add_u32 s40, s40, 7340032
    s_mov_b32 s34, s35
    s_mul_i32 s42, s2, 3635633
    s_bfe_u32 s42, s42, 0x7000d
    s_sub_u32 s43, s30, 1
    s_xor_b32 s42, s42, s43
    s_lshl_b32 s42, s42, 10
    s_waitcnt lgkmcnt(0)
    s_add_u32 s32, s6, s40
    s_addc_u32 s33, s7, 0
    s_and_b32 s33, s33, 0xffff
    buffer_load_dwordx4 v[8:11], v1, s[32:35], s42 offen nt
    s_xor_b32 s41, s42, 8192
    buffer_load_dwordx4 v[12:15], v1, s[32:35], s41 offen nt
    s_xor_b32 s41, s42, 16384
    buffer_load_dwordx4 v[16:19], v1, s[32:35], s41 offen nt
    s_branch L_att
L_aux:
    v_and_b32 v2, 15, v0
    v_lshrrev_b32 v3, 4, v0
    v_lshl_add_u32 v4, v2, 2, v3
    s_lshl_b32 s40, s29, 7
    v_lshl_add_u32 v5, v4, 1, s40
    v_lshlrev_b32 v6, 13, v3
    v_lshl_add_u32 v6, v2, 4, v6
    s_lshl_b32 s40, s29, 19
    s_lshl_b32 s41, s28, 8
    s_add_u32 s40, s40, s41
    s_sub_u32 s34, 4194304, s40
    s_mov_b32 s41, 0
    s_mov_b32 s42, 32768
    s_waitcnt lgkmcnt(0)
    global_load_dwordx4 v[136:139], v1, s[4:5]
    global_load_ushort v160, v5, s[4:5]
    s_add_u32 s32, s10, s40
    s_addc_u32 s33, s11, 0
    s_and_b32 s33, s33, 0xffff
    buffer_load_dwordx4 v[8:11], v6, s[32:35], s41 offen nt
    s_add_u32 s41, s41, s42
    buffer_load_dwordx4 v[12:15], v6, s[32:35], s41 offen nt
    s_add_u32 s41, s41, s42
    buffer_load_dwordx4 v[16:19], v6, s[32:35], s41 offen nt
    s_add_u32 s41, s41, s42
    buffer_load_dwordx4 v[20:23], v6, s[32:35], s41 offen nt
    s_add_u32 s41, s41, s42
    buffer_load_dwordx4 v[24:27], v6, s[32:35], s41 offen nt
    s_add_u32 s41, s41, s42
    buffer_load_dwordx4 v[28:31], v6, s[32:35], s41 offen nt
    s_add_u32 s41, s41, s42
    buffer_load_dwordx4 v[32:35], v6, s[32:35], s41 offen nt
    s_add_u32 s41, s41, s42
    buffer_load_dwordx4 v[36:39], v6, s[32:35], s41 offen nt
    s_add_u32 s41, s41, s42
    buffer_load_dwordx4 v[40:43], v6, s[32:35], s41 offen nt
    s_add_u32 s41, s41, s42
    buffer_load_dwordx4 v[44:47], v6, s[32:35], s41 offen nt
    s_add_u32 s41, s41, s42
    buffer_load_dwordx4 v[48:51], v6, s[32:35], s41 offen nt
    s_add_u32 s41, s41, s42
    buffer_load_dwordx4 v[52:55], v6, s[32:35], s41 offen nt
    s_add_u32 s41, s41, s42
    buffer_load_dwordx4 v[56:59], v6, s[32:35], s41 offen nt
    s_add_u32 s41, s41, s42
    buffer_load_dwordx4 v[60:63], v6, s[32:35], s41 offen nt
    s_add_u32 s41, s41, s42
    buffer_load_dwordx4 v[64:67], v6, s[32:35], s41 offen nt
    s_add_u32 s41, s41, s42
    buffer_load_dwordx4 v[68:71], v6, s[32:35], s41 offen nt
    s_and_b32 s50, s28, 7
    s_lshl_b32 s50, s50, 2
    s_lshr_b32 s51, s28, 3
    s_add_u32 s50, s50, s51
    s_mul_i32 s50, s50, 43
    s_add_u32 s51, s50, 43
    s_lshr_b32 s50, s50, 3
    s_lshr_b32 s51, s51, 3
    s_sub_u32 s51, s51, s50
    s_sub_u32 s42, s51, 1
    v_lshrrev_b32 v7, 1, v2
    v_min_u32 v7, s42, v7
    v_add_u32 v7, s50, v7
    v_lshlrev_b32 v7, 4, v7
    s_lshl_b32 s41, s29, 6
    v_add_u32 v165, s41, v3
    s_movk_i32 s41, 2752
    v_mul_lo_u32 v165, v165, s41
    v_add_u32 v7, v7, v165
    v_and_b32 v165, 1, v0
    v_cmp_eq_u32 vcc, 0, v165
    v_mov_b32 v162, s16
    v_mov_b32 v163, s17
    v_mov_b32 v164, s18
    v_mov_b32 v165, s19
    v_cndmask_b32 v162, v164, v162, vcc
    v_cndmask_b32 v163, v165, v163, vcc
    v_add_co_u32 v162, vcc, v162, v7
    s_nop 1
    v_addc_co_u32 v163, vcc, 0, v163, vcc
    s_movk_i32 s40, 11008
    s_mov_b32 s41, 0
    global_load_dwordx4 v[72:75], v[162:163], off nt
    v_lshl_add_u64 v[162:163], v[162:163], 0, s[40:41]
    global_load_dwordx4 v[76:79], v[162:163], off nt
    v_lshl_add_u64 v[162:163], v[162:163], 0, s[40:41]
    global_load_dwordx4 v[80:83], v[162:163], off nt
    v_lshl_add_u64 v[162:163], v[162:163], 0, s[40:41]
    global_load_dwordx4 v[84:87], v[162:163], off nt
    v_lshl_add_u64 v[162:163], v[162:163], 0, s[40:41]
    global_load_dwordx4 v[88:91], v[162:163], off nt
    v_lshl_add_u64 v[162:163], v[162:163], 0, s[40:41]
    global_load_dwordx4 v[92:95], v[162:163], off nt
    v_lshl_add_u64 v[162:163], v[162:163], 0, s[40:41]
    global_load_dwordx4 v[96:99], v[162:163], off nt
    v_lshl_add_u64 v[162:163], v[162:163], 0, s[40:41]
    global_load_dwordx4 v[100:103], v[162:163], off nt
    v_lshl_add_u64 v[162:163], v[162:163], 0, s[40:41]
    global_load_dwordx4 v[104:107], v[162:163], off nt
    v_lshl_add_u64 v[162:163], v[162:163], 0, s[40:41]
    global_load_dwordx4 v[108:111], v[162:163], off nt
    v_lshl_add_u64 v[162:163], v[162:163], 0, s[40:41]
    global_load_dwordx4 v[112:115], v[162:163], off nt
    v_lshl_add_u64 v[162:163], v[162:163], 0, s[40:41]
    global_load_dwordx4 v[116:119], v[162:163], off nt
    v_lshl_add_u64 v[162:163], v[162:163], 0, s[40:41]
    global_load_dwordx4 v[120:123], v[162:163], off nt
    v_lshl_add_u64 v[162:163], v[162:163], 0, s[40:41]
    global_load_dwordx4 v[124:127], v[162:163], off nt
    v_lshl_add_u64 v[162:163], v[162:163], 0, s[40:41]
    global_load_dwordx4 v[128:131], v[162:163], off nt
    v_lshl_add_u64 v[162:163], v[162:163], 0, s[40:41]
    global_load_dwordx4 v[132:135], v[162:163], off nt
    v_mov_b32 v4, 0
    v_mov_b32 v5, 0
    v_mov_b32 v7, 29120
    ds_write_b64 v7, v[4:5]
    ds_write_b64 v7, v[4:5] offset:8
    ds_write_b64 v7, v[4:5] offset:16
    s_getreg_b32 s31, hwreg(HW_REG_XCC_ID, 0, 4)
    s_and_b32 s31, s31, 7
    s_and_b32 s59, s28, 7
    v_and_b32 v167, 7, v0
    v_lshlrev_b32 v167, 5, v167
    s_lshl_b32 s52, s28, 3
    s_add_u32 s52, s52, s29
    s_waitcnt lgkmcnt(0)
    s_barrier
    v_mov_b32 v140, 0
    v_mov_b32 v141, 0
    v_mov_b32 v142, 0
    v_mov_b32 v143, 0
    v_mov_b32 v144, 0
    v_mov_b32 v145, 0
    v_mov_b32 v146, 0
    v_mov_b32 v147, 0
    v_mov_b32 v148, 0
    v_mov_b32 v149, 0
    v_mov_b32 v150, 0
    v_mov_b32 v151, 0
    v_mov_b32 v152, 0
    v_mov_b32 v153, 0
    v_mov_b32 v154, 0
    v_mov_b32 v155, 0
    s_mov_b32 s48, 0xffff0000
    s_waitcnt vmcnt(32)
    v_and_b32 v156, s48, v136
    v_and_b32 v157, s48, v137
    v_and_b32 v158, s48, v138
    v_and_b32 v159, s48, v139
    v_lshlrev_b32 v136, 16, v136
    v_lshlrev_b32 v137, 16, v137
    v_lshlrev_b32 v138, 16, v138
    v_lshlrev_b32 v139, 16, v139
    v_add_f32 v4, v136, v156
    v_add_f32 v5, v137, v157
    v_add_f32 v6, v138, v158
    v_add_f32 v166, v139, v159
    v_add_f32 v4, v4, v5
    v_add_f32 v6, v6, v166
    v_add_f32 v4, v4, v6
    s_nop 1
    v_add_f32_dpp v4, v4, v4 quad_perm:[1,0,3,2] row_mask:0xf bank_mask:0xf
    s_nop 1
    v_add_f32_dpp v4, v4, v4 quad_perm:[2,3,0,1] row_mask:0xf bank_mask:0xf
    s_nop 1
    v_add_f32_dpp v4, v4, v4 row_ror:4 row_mask:0xf bank_mask:0xf
    s_nop 1
    v_add_f32_dpp v4, v4, v4 row_ror:8 row_mask:0xf bank_mask:0xf
    v_mov_b32 v5, v4
    s_nop 1
    v_permlane16_swap_b32 v4, v5
    v_add_f32 v4, v4, v5
    v_mov_b32 v5, v4
    s_nop 1
    v_permlane32_swap_b32 v4, v5
    v_add_f32 v4, v4, v5
    v_mul_f32 v4, 0x3b000000, v4
    v_sub_f32 v136, v136, v4
    v_sub_f32 v137, v137, v4
    v_sub_f32 v138, v138, v4
    v_sub_f32 v139, v139, v4
    v_sub_f32 v156, v156, v4
    v_sub_f32 v157, v157, v4
    v_sub_f32 v158, v158, v4
    v_sub_f32 v159, v159, v4
    v_mul_f32 v6, v136, v136
    v_mul_f32 v166, v156, v156
    v_fmac_f32 v6, v137, v137
    v_fmac_f32 v166, v157, v157
    v_fmac_f32 v6, v138, v138
    v_fmac_f32 v166, v158, v158
    v_fmac_f32 v6, v139, v139
    v_fmac_f32 v166, v159, v159
    v_add_f32 v6, v6, v166
    s_nop 1
    v_add_f32_dpp v6, v6, v6 quad_perm:[1,0,3,2] row_mask:0xf bank_mask:0xf
    s_nop 1
    v_add_f32_dpp v6, v6, v6 quad_perm:[2,3,0,1] row_mask:0xf bank_mask:0xf
    s_nop 1
    v_add_f32_dpp v6, v6, v6 row_ror:4 row_mask:0xf bank_mask:0xf
    s_nop 1
    v_add_f32_dpp v6, v6, v6 row_ror:8 row_mask:0xf bank_mask:0xf
    v_mov_b32 v5, v6
    s_nop 1
    v_permlane16_swap_b32 v6, v5
    v_add_f32 v6, v6, v5
    v_mov_b32 v5, v6
    s_nop 1
    v_permlane32_swap_b32 v6, v5
    v_add_f32 v6, v6, v5
    v_mul_f32 v6, 0x3b000000, v6
    v_cvt_pk_bf16_f32 v5, v4, v6
    v_lshlrev_b32 v4, 16, v5
    v_and_b32 v6, s48, v5
    v_add_f32 v6, 0x3727c5ac, v6
    v_cvt_pk_bf16_f32 v6, v6, v6
    v_and_b32 v6, s48, v6
    v_sqrt_f32 v6, v6
    v_lshlrev_b32 v160, 16, v160
    v_sub_f32 v160, v160, v4
    v_cvt_pk_bf16_f32 v6, v6, v160
    v_and_b32 v160, s48, v6
    v_lshlrev_b32 v6, 16, v6
    v_rcp_f32 v6, v6
    s_nop 0
    v_mul_f32 v160, v160, v6
    v_cvt_pk_bf16_f32 v156, v160, 0
    v_lshlrev_b32 v157, 16, v156
    s_waitcnt vmcnt(31)
    v_dot2c_f32_bf16_dpp v140, v156, v8 row_newbcast:0 row_mask:0xf bank_mask:0xf
    v_dot2c_f32_bf16_dpp v141, v157, v8 row_newbcast:0 row_mask:0xf bank_mask:0xf
    v_dot2c_f32_bf16_dpp v142, v156, v9 row_newbcast:0 row_mask:0xf bank_mask:0xf
    v_dot2c_f32_bf16_dpp v143, v157, v9 row_newbcast:0 row_mask:0xf bank_mask:0xf
    v_dot2c_f32_bf16_dpp v144, v156, v10 row_newbcast:0 row_mask:0xf bank_mask:0xf
    v_dot2c_f32_bf16_dpp v145, v157, v10 row_newbcast:0 row_mask:0xf bank_mask:0xf
    v_dot2c_f32_bf16_dpp v146, v156, v11 row_newbcast:0 row_mask:0xf bank_mask:0xf
    v_dot2c_f32_bf16_dpp v147, v157, v11 row_newbcast:0 row_mask:0xf bank_mask:0xf
    s_waitcnt vmcnt(30)
    v_dot2c_f32_bf16_dpp v140, v156, v12 row_newbcast:1 row_mask:0xf bank_mask:0xf
    v_dot2c_f32_bf16_dpp v141, v157, v12 row_newbcast:1 row_mask:0xf bank_mask:0xf
    v_dot2c_f32_bf16_dpp v142, v156, v13 row_newbcast:1 row_mask:0xf bank_mask:0xf
    v_dot2c_f32_bf16_dpp v143, v157, v13 row_newbcast:1 row_mask:0xf bank_mask:0xf
    v_dot2c_f32_bf16_dpp v144, v156, v14 row_newbcast:1 row_mask:0xf bank_mask:0xf
    v_dot2c_f32_bf16_dpp v145, v157, v14 row_newbcast:1 row_mask:0xf bank_mask:0xf
    v_dot2c_f32_bf16_dpp v146, v156, v15 row_newbcast:1 row_mask:0xf bank_mask:0xf
    v_dot2c_f32_bf16_dpp v147, v157, v15 row_newbcast:1 row_mask:0xf bank_mask:0xf
    s_waitcnt vmcnt(29)
    v_dot2c_f32_bf16_dpp v140, v156, v16 row_newbcast:2 row_mask:0xf bank_mask:0xf
    v_dot2c_f32_bf16_dpp v141, v157, v16 row_newbcast:2 row_mask:0xf bank_mask:0xf
    v_dot2c_f32_bf16_dpp v142, v156, v17 row_newbcast:2 row_mask:0xf bank_mask:0xf
    v_dot2c_f32_bf16_dpp v143, v157, v17 row_newbcast:2 row_mask:0xf bank_mask:0xf
    v_dot2c_f32_bf16_dpp v144, v156, v18 row_newbcast:2 row_mask:0xf bank_mask:0xf
    v_dot2c_f32_bf16_dpp v145, v157, v18 row_newbcast:2 row_mask:0xf bank_mask:0xf
    v_dot2c_f32_bf16_dpp v146, v156, v19 row_newbcast:2 row_mask:0xf bank_mask:0xf
    v_dot2c_f32_bf16_dpp v147, v157, v19 row_newbcast:2 row_mask:0xf bank_mask:0xf
    s_waitcnt vmcnt(28)
    v_dot2c_f32_bf16_dpp v140, v156, v20 row_newbcast:3 row_mask:0xf bank_mask:0xf
    v_dot2c_f32_bf16_dpp v141, v157, v20 row_newbcast:3 row_mask:0xf bank_mask:0xf
    v_dot2c_f32_bf16_dpp v142, v156, v21 row_newbcast:3 row_mask:0xf bank_mask:0xf
    v_dot2c_f32_bf16_dpp v143, v157, v21 row_newbcast:3 row_mask:0xf bank_mask:0xf
    v_dot2c_f32_bf16_dpp v144, v156, v22 row_newbcast:3 row_mask:0xf bank_mask:0xf
    v_dot2c_f32_bf16_dpp v145, v157, v22 row_newbcast:3 row_mask:0xf bank_mask:0xf
    v_dot2c_f32_bf16_dpp v146, v156, v23 row_newbcast:3 row_mask:0xf bank_mask:0xf
    v_dot2c_f32_bf16_dpp v147, v157, v23 row_newbcast:3 row_mask:0xf bank_mask:0xf
    s_waitcnt vmcnt(27)
    v_dot2c_f32_bf16_dpp v140, v156, v24 row_newbcast:4 row_mask:0xf bank_mask:0xf
    v_dot2c_f32_bf16_dpp v141, v157, v24 row_newbcast:4 row_mask:0xf bank_mask:0xf
    v_dot2c_f32_bf16_dpp v142, v156, v25 row_newbcast:4 row_mask:0xf bank_mask:0xf
    v_dot2c_f32_bf16_dpp v143, v157, v25 row_newbcast:4 row_mask:0xf bank_mask:0xf
    v_dot2c_f32_bf16_dpp v144, v156, v26 row_newbcast:4 row_mask:0xf bank_mask:0xf
    v_dot2c_f32_bf16_dpp v145, v157, v26 row_newbcast:4 row_mask:0xf bank_mask:0xf
    v_dot2c_f32_bf16_dpp v146, v156, v27 row_newbcast:4 row_mask:0xf bank_mask:0xf
    v_dot2c_f32_bf16_dpp v147, v157, v27 row_newbcast:4 row_mask:0xf bank_mask:0xf
    s_waitcnt vmcnt(26)
    v_dot2c_f32_bf16_dpp v140, v156, v28 row_newbcast:5 row_mask:0xf bank_mask:0xf
    v_dot2c_f32_bf16_dpp v141, v157, v28 row_newbcast:5 row_mask:0xf bank_mask:0xf
    v_dot2c_f32_bf16_dpp v142, v156, v29 row_newbcast:5 row_mask:0xf bank_mask:0xf
    v_dot2c_f32_bf16_dpp v143, v157, v29 row_newbcast:5 row_mask:0xf bank_mask:0xf
    v_dot2c_f32_bf16_dpp v144, v156, v30 row_newbcast:5 row_mask:0xf bank_mask:0xf
    v_dot2c_f32_bf16_dpp v145, v157, v30 row_newbcast:5 row_mask:0xf bank_mask:0xf
    v_dot2c_f32_bf16_dpp v146, v156, v31 row_newbcast:5 row_mask:0xf bank_mask:0xf
    v_dot2c_f32_bf16_dpp v147, v157, v31 row_newbcast:5 row_mask:0xf bank_mask:0xf
    s_waitcnt vmcnt(25)
    v_dot2c_f32_bf16_dpp v140, v156, v32 row_newbcast:6 row_mask:0xf bank_mask:0xf
    v_dot2c_f32_bf16_dpp v141, v157, v32 row_newbcast:6 row_mask:0xf bank_mask:0xf
    v_dot2c_f32_bf16_dpp v142, v156, v33 row_newbcast:6 row_mask:0xf bank_mask:0xf
    v_dot2c_f32_bf16_dpp v143, v157, v33 row_newbcast:6 row_mask:0xf bank_mask:0xf
    v_dot2c_f32_bf16_dpp v144, v156, v34 row_newbcast:6 row_mask:0xf bank_mask:0xf
    v_dot2c_f32_bf16_dpp v145, v157, v34 row_newbcast:6 row_mask:0xf bank_mask:0xf
    v_dot2c_f32_bf16_dpp v146, v156, v35 row_newbcast:6 row_mask:0xf bank_mask:0xf
    v_dot2c_f32_bf16_dpp v147, v157, v35 row_newbcast:6 row_mask:0xf bank_mask:0xf
    s_waitcnt vmcnt(24)
    v_dot2c_f32_bf16_dpp v140, v156, v36 row_newbcast:7 row_mask:0xf bank_mask:0xf
    v_dot2c_f32_bf16_dpp v141, v157, v36 row_newbcast:7 row_mask:0xf bank_mask:0xf
    v_dot2c_f32_bf16_dpp v142, v156, v37 row_newbcast:7 row_mask:0xf bank_mask:0xf
    v_dot2c_f32_bf16_dpp v143, v157, v37 row_newbcast:7 row_mask:0xf bank_mask:0xf
    v_dot2c_f32_bf16_dpp v144, v156, v38 row_newbcast:7 row_mask:0xf bank_mask:0xf
    v_dot2c_f32_bf16_dpp v145, v157, v38 row_newbcast:7 row_mask:0xf bank_mask:0xf
    v_dot2c_f32_bf16_dpp v146, v156, v39 row_newbcast:7 row_mask:0xf bank_mask:0xf
    v_dot2c_f32_bf16_dpp v147, v157, v39 row_newbcast:7 row_mask:0xf bank_mask:0xf
    s_waitcnt vmcnt(23)
    v_dot2c_f32_bf16_dpp v140, v156, v40 row_newbcast:8 row_mask:0xf bank_mask:0xf
    v_dot2c_f32_bf16_dpp v141, v157, v40 row_newbcast:8 row_mask:0xf bank_mask:0xf
    v_dot2c_f32_bf16_dpp v142, v156, v41 row_newbcast:8 row_mask:0xf bank_mask:0xf
    v_dot2c_f32_bf16_dpp v143, v157, v41 row_newbcast:8 row_mask:0xf bank_mask:0xf
    v_dot2c_f32_bf16_dpp v144, v156, v42 row_newbcast:8 row_mask:0xf bank_mask:0xf
    v_dot2c_f32_bf16_dpp v145, v157, v42 row_newbcast:8 row_mask:0xf bank_mask:0xf
    v_dot2c_f32_bf16_dpp v146, v156, v43 row_newbcast:8 row_mask:0xf bank_mask:0xf
    v_dot2c_f32_bf16_dpp v147, v157, v43 row_newbcast:8 row_mask:0xf bank_mask:0xf
    s_waitcnt vmcnt(22)
    v_dot2c_f32_bf16_dpp v140, v156, v44 row_newbcast:9 row_mask:0xf bank_mask:0xf
    v_dot2c_f32_bf16_dpp v141, v157, v44 row_newbcast:9 row_mask:0xf bank_mask:0xf
    v_dot2c_f32_bf16_dpp v142, v156, v45 row_newbcast:9 row_mask:0xf bank_mask:0xf
    v_dot2c_f32_bf16_dpp v143, v157, v45 row_newbcast:9 row_mask:0xf bank_mask:0xf
    v_dot2c_f32_bf16_dpp v144, v156, v46 row_newbcast:9 row_mask:0xf bank_mask:0xf
    v_dot2c_f32_bf16_dpp v145, v157, v46 row_newbcast:9 row_mask:0xf bank_mask:0xf
    v_dot2c_f32_bf16_dpp v146, v156, v47 row_newbcast:9 row_mask:0xf bank_mask:0xf
    v_dot2c_f32_bf16_dpp v147, v157, v47 row_newbcast:9 row_mask:0xf bank_mask:0xf
    s_waitcnt vmcnt(21)
    v_dot2c_f32_bf16_dpp v140, v156, v48 row_newbcast:10 row_mask:0xf bank_mask:0xf
    v_dot2c_f32_bf16_dpp v141, v157, v48 row_newbcast:10 row_mask:0xf bank_mask:0xf
    v_dot2c_f32_bf16_dpp v142, v156, v49 row_newbcast:10 row_mask:0xf bank_mask:0xf
    v_dot2c_f32_bf16_dpp v143, v157, v49 row_newbcast:10 row_mask:0xf bank_mask:0xf
    v_dot2c_f32_bf16_dpp v144, v156, v50 row_newbcast:10 row_mask:0xf bank_mask:0xf
    v_dot2c_f32_bf16_dpp v145, v157, v50 row_newbcast:10 row_mask:0xf bank_mask:0xf
    v_dot2c_f32_bf16_dpp v146, v156, v51 row_newbcast:10 row_mask:0xf bank_mask:0xf
    v_dot2c_f32_bf16_dpp v147, v157, v51 row_newbcast:10 row_mask:0xf bank_mask:0xf
    s_waitcnt vmcnt(20)
    v_dot2c_f32_bf16_dpp v140, v156, v52 row_newbcast:11 row_mask:0xf bank_mask:0xf
    v_dot2c_f32_bf16_dpp v141, v157, v52 row_newbcast:11 row_mask:0xf bank_mask:0xf
    v_dot2c_f32_bf16_dpp v142, v156, v53 row_newbcast:11 row_mask:0xf bank_mask:0xf
    v_dot2c_f32_bf16_dpp v143, v157, v53 row_newbcast:11 row_mask:0xf bank_mask:0xf
    v_dot2c_f32_bf16_dpp v144, v156, v54 row_newbcast:11 row_mask:0xf bank_mask:0xf
    v_dot2c_f32_bf16_dpp v145, v157, v54 row_newbcast:11 row_mask:0xf bank_mask:0xf
    v_dot2c_f32_bf16_dpp v146, v156, v55 row_newbcast:11 row_mask:0xf bank_mask:0xf
    v_dot2c_f32_bf16_dpp v147, v157, v55 row_newbcast:11 row_mask:0xf bank_mask:0xf
    s_waitcnt vmcnt(19)
    v_dot2c_f32_bf16_dpp v140, v156, v56 row_newbcast:12 row_mask:0xf bank_mask:0xf
    v_dot2c_f32_bf16_dpp v141, v157, v56 row_newbcast:12 row_mask:0xf bank_mask:0xf
    v_dot2c_f32_bf16_dpp v142, v156, v57 row_newbcast:12 row_mask:0xf bank_mask:0xf
    v_dot2c_f32_bf16_dpp v143, v157, v57 row_newbcast:12 row_mask:0xf bank_mask:0xf
    v_dot2c_f32_bf16_dpp v144, v156, v58 row_newbcast:12 row_mask:0xf bank_mask:0xf
    v_dot2c_f32_bf16_dpp v145, v157, v58 row_newbcast:12 row_mask:0xf bank_mask:0xf
    v_dot2c_f32_bf16_dpp v146, v156, v59 row_newbcast:12 row_mask:0xf bank_mask:0xf
    v_dot2c_f32_bf16_dpp v147, v157, v59 row_newbcast:12 row_mask:0xf bank_mask:0xf
    s_waitcnt vmcnt(18)
    v_dot2c_f32_bf16_dpp v140, v156, v60 row_newbcast:13 row_mask:0xf bank_mask:0xf
    v_dot2c_f32_bf16_dpp v141, v157, v60 row_newbcast:13 row_mask:0xf bank_mask:0xf
    v_dot2c_f32_bf16_dpp v142, v156, v61 row_newbcast:13 row_mask:0xf bank_mask:0xf
    v_dot2c_f32_bf16_dpp v143, v157, v61 row_newbcast:13 row_mask:0xf bank_mask:0xf
    v_dot2c_f32_bf16_dpp v144, v156, v62 row_newbcast:13 row_mask:0xf bank_mask:0xf
    v_dot2c_f32_bf16_dpp v145, v157, v62 row_newbcast:13 row_mask:0xf bank_mask:0xf
    v_dot2c_f32_bf16_dpp v146, v156, v63 row_newbcast:13 row_mask:0xf bank_mask:0xf
    v_dot2c_f32_bf16_dpp v147, v157, v63 row_newbcast:13 row_mask:0xf bank_mask:0xf
    s_waitcnt vmcnt(17)
    v_dot2c_f32_bf16_dpp v140, v156, v64 row_newbcast:14 row_mask:0xf bank_mask:0xf
    v_dot2c_f32_bf16_dpp v141, v157, v64 row_newbcast:14 row_mask:0xf bank_mask:0xf
    v_dot2c_f32_bf16_dpp v142, v156, v65 row_newbcast:14 row_mask:0xf bank_mask:0xf
    v_dot2c_f32_bf16_dpp v143, v157, v65 row_newbcast:14 row_mask:0xf bank_mask:0xf
    v_dot2c_f32_bf16_dpp v144, v156, v66 row_newbcast:14 row_mask:0xf bank_mask:0xf
    v_dot2c_f32_bf16_dpp v145, v157, v66 row_newbcast:14 row_mask:0xf bank_mask:0xf
    v_dot2c_f32_bf16_dpp v146, v156, v67 row_newbcast:14 row_mask:0xf bank_mask:0xf
    v_dot2c_f32_bf16_dpp v147, v157, v67 row_newbcast:14 row_mask:0xf bank_mask:0xf
    s_waitcnt vmcnt(16)
    v_dot2c_f32_bf16_dpp v140, v156, v68 row_newbcast:15 row_mask:0xf bank_mask:0xf
    v_dot2c_f32_bf16_dpp v141, v157, v68 row_newbcast:15 row_mask:0xf bank_mask:0xf
    v_dot2c_f32_bf16_dpp v142, v156, v69 row_newbcast:15 row_mask:0xf bank_mask:0xf
    v_dot2c_f32_bf16_dpp v143, v157, v69 row_newbcast:15 row_mask:0xf bank_mask:0xf
    v_dot2c_f32_bf16_dpp v144, v156, v70 row_newbcast:15 row_mask:0xf bank_mask:0xf
    v_dot2c_f32_bf16_dpp v145, v157, v70 row_newbcast:15 row_mask:0xf bank_mask:0xf
    v_dot2c_f32_bf16_dpp v146, v156, v71 row_newbcast:15 row_mask:0xf bank_mask:0xf
    v_dot2c_f32_bf16_dpp v147, v157, v71 row_newbcast:15 row_mask:0xf bank_mask:0xf
    s_waitcnt vmcnt(15)
    v_dot2c_f32_bf16_dpp v148, v156, v72 row_newbcast:0 row_mask:0xf bank_mask:0xf
    v_dot2c_f32_bf16_dpp v149, v157, v72 row_newbcast:0 row_mask:0xf bank_mask:0xf
    v_dot2c_f32_bf16_dpp v150, v156, v73 row_newbcast:0 row_mask:0xf bank_mask:0xf
    v_dot2c_f32_bf16_dpp v151, v157, v73 row_newbcast:0 row_mask:0xf bank_mask:0xf
    v_dot2c_f32_bf16_dpp v152, v156, v74 row_newbcast:0 row_mask:0xf bank_mask:0xf
    v_dot2c_f32_bf16_dpp v153, v157, v74 row_newbcast:0 row_mask:0xf bank_mask:0xf
    v_dot2c_f32_bf16_dpp v154, v156, v75 row_newbcast:0 row_mask:0xf bank_mask:0xf
    v_dot2c_f32_bf16_dpp v155, v157, v75 row_newbcast:0 row_mask:0xf bank_mask:0xf
    s_waitcnt vmcnt(14)
    v_dot2c_f32_bf16_dpp v148, v156, v76 row_newbcast:1 row_mask:0xf bank_mask:0xf
    v_dot2c_f32_bf16_dpp v149, v157, v76 row_newbcast:1 row_mask:0xf bank_mask:0xf
    v_dot2c_f32_bf16_dpp v150, v156, v77 row_newbcast:1 row_mask:0xf bank_mask:0xf
    v_dot2c_f32_bf16_dpp v151, v157, v77 row_newbcast:1 row_mask:0xf bank_mask:0xf
    v_dot2c_f32_bf16_dpp v152, v156, v78 row_newbcast:1 row_mask:0xf bank_mask:0xf
    v_dot2c_f32_bf16_dpp v153, v157, v78 row_newbcast:1 row_mask:0xf bank_mask:0xf
    v_dot2c_f32_bf16_dpp v154, v156, v79 row_newbcast:1 row_mask:0xf bank_mask:0xf
    v_dot2c_f32_bf16_dpp v155, v157, v79 row_newbcast:1 row_mask:0xf bank_mask:0xf
    s_waitcnt vmcnt(13)
    v_dot2c_f32_bf16_dpp v148, v156, v80 row_newbcast:2 row_mask:0xf bank_mask:0xf
    v_dot2c_f32_bf16_dpp v149, v157, v80 row_newbcast:2 row_mask:0xf bank_mask:0xf
    v_dot2c_f32_bf16_dpp v150, v156, v81 row_newbcast:2 row_mask:0xf bank_mask:0xf
    v_dot2c_f32_bf16_dpp v151, v157, v81 row_newbcast:2 row_mask:0xf bank_mask:0xf
    v_dot2c_f32_bf16_dpp v152, v156, v82 row_newbcast:2 row_mask:0xf bank_mask:0xf
    v_dot2c_f32_bf16_dpp v153, v157, v82 row_newbcast:2 row_mask:0xf bank_mask:0xf
    v_dot2c_f32_bf16_dpp v154, v156, v83 row_newbcast:2 row_mask:0xf bank_mask:0xf
    v_dot2c_f32_bf16_dpp v155, v157, v83 row_newbcast:2 row_mask:0xf bank_mask:0xf
    s_waitcnt vmcnt(12)
    v_dot2c_f32_bf16_dpp v148, v156, v84 row_newbcast:3 row_mask:0xf bank_mask:0xf
    v_dot2c_f32_bf16_dpp v149, v157, v84 row_newbcast:3 row_mask:0xf bank_mask:0xf
    v_dot2c_f32_bf16_dpp v150, v156, v85 row_newbcast:3 row_mask:0xf bank_mask:0xf
    v_dot2c_f32_bf16_dpp v151, v157, v85 row_newbcast:3 row_mask:0xf bank_mask:0xf
    v_dot2c_f32_bf16_dpp v152, v156, v86 row_newbcast:3 row_mask:0xf bank_mask:0xf
    v_dot2c_f32_bf16_dpp v153, v157, v86 row_newbcast:3 row_mask:0xf bank_mask:0xf
    v_dot2c_f32_bf16_dpp v154, v156, v87 row_newbcast:3 row_mask:0xf bank_mask:0xf
    v_dot2c_f32_bf16_dpp v155, v157, v87 row_newbcast:3 row_mask:0xf bank_mask:0xf
    s_waitcnt vmcnt(11)
    v_dot2c_f32_bf16_dpp v148, v156, v88 row_newbcast:4 row_mask:0xf bank_mask:0xf
    v_dot2c_f32_bf16_dpp v149, v157, v88 row_newbcast:4 row_mask:0xf bank_mask:0xf
    v_dot2c_f32_bf16_dpp v150, v156, v89 row_newbcast:4 row_mask:0xf bank_mask:0xf
    v_dot2c_f32_bf16_dpp v151, v157, v89 row_newbcast:4 row_mask:0xf bank_mask:0xf
    v_dot2c_f32_bf16_dpp v152, v156, v90 row_newbcast:4 row_mask:0xf bank_mask:0xf
    v_dot2c_f32_bf16_dpp v153, v157, v90 row_newbcast:4 row_mask:0xf bank_mask:0xf
    v_dot2c_f32_bf16_dpp v154, v156, v91 row_newbcast:4 row_mask:0xf bank_mask:0xf
    v_dot2c_f32_bf16_dpp v155, v157, v91 row_newbcast:4 row_mask:0xf bank_mask:0xf
    s_waitcnt vmcnt(10)
    v_dot2c_f32_bf16_dpp v148, v156, v92 row_newbcast:5 row_mask:0xf bank_mask:0xf
    v_dot2c_f32_bf16_dpp v149, v157, v92 row_newbcast:5 row_mask:0xf bank_mask:0xf
    v_dot2c_f32_bf16_dpp v150, v156, v93 row_newbcast:5 row_mask:0xf bank_mask:0xf
    v_dot2c_f32_bf16_dpp v151, v157, v93 row_newbcast:5 row_mask:0xf bank_mask:0xf
    v_dot2c_f32_bf16_dpp v152, v156, v94 row_newbcast:5 row_mask:0xf bank_mask:0xf
    v_dot2c_f32_bf16_dpp v153, v157, v94 row_newbcast:5 row_mask:0xf bank_mask:0xf
    v_dot2c_f32_bf16_dpp v154, v156, v95 row_newbcast:5 row_mask:0xf bank_mask:0xf
    v_dot2c_f32_bf16_dpp v155, v157, v95 row_newbcast:5 row_mask:0xf bank_mask:0xf
    s_waitcnt vmcnt(9)
    v_dot2c_f32_bf16_dpp v148, v156, v96 row_newbcast:6 row_mask:0xf bank_mask:0xf
    v_dot2c_f32_bf16_dpp v149, v157, v96 row_newbcast:6 row_mask:0xf bank_mask:0xf
    v_dot2c_f32_bf16_dpp v150, v156, v97 row_newbcast:6 row_mask:0xf bank_mask:0xf
    v_dot2c_f32_bf16_dpp v151, v157, v97 row_newbcast:6 row_mask:0xf bank_mask:0xf
    v_dot2c_f32_bf16_dpp v152, v156, v98 row_newbcast:6 row_mask:0xf bank_mask:0xf
    v_dot2c_f32_bf16_dpp v153, v157, v98 row_newbcast:6 row_mask:0xf bank_mask:0xf
    v_dot2c_f32_bf16_dpp v154, v156, v99 row_newbcast:6 row_mask:0xf bank_mask:0xf
    v_dot2c_f32_bf16_dpp v155, v157, v99 row_newbcast:6 row_mask:0xf bank_mask:0xf
    s_waitcnt vmcnt(8)
    v_dot2c_f32_bf16_dpp v148, v156, v100 row_newbcast:7 row_mask:0xf bank_mask:0xf
    v_dot2c_f32_bf16_dpp v149, v157, v100 row_newbcast:7 row_mask:0xf bank_mask:0xf
    v_dot2c_f32_bf16_dpp v150, v156, v101 row_newbcast:7 row_mask:0xf bank_mask:0xf
    v_dot2c_f32_bf16_dpp v151, v157, v101 row_newbcast:7 row_mask:0xf bank_mask:0xf
    v_dot2c_f32_bf16_dpp v152, v156, v102 row_newbcast:7 row_mask:0xf bank_mask:0xf
    v_dot2c_f32_bf16_dpp v153, v157, v102 row_newbcast:7 row_mask:0xf bank_mask:0xf
    v_dot2c_f32_bf16_dpp v154, v156, v103 row_newbcast:7 row_mask:0xf bank_mask:0xf
    v_dot2c_f32_bf16_dpp v155, v157, v103 row_newbcast:7 row_mask:0xf bank_mask:0xf
    s_waitcnt vmcnt(7)
    v_dot2c_f32_bf16_dpp v148, v156, v104 row_newbcast:8 row_mask:0xf bank_mask:0xf
    v_dot2c_f32_bf16_dpp v149, v157, v104 row_newbcast:8 row_mask:0xf bank_mask:0xf
    v_dot2c_f32_bf16_dpp v150, v156, v105 row_newbcast:8 row_mask:0xf bank_mask:0xf
    v_dot2c_f32_bf16_dpp v151, v157, v105 row_newbcast:8 row_mask:0xf bank_mask:0xf
    v_dot2c_f32_bf16_dpp v152, v156, v106 row_newbcast:8 row_mask:0xf bank_mask:0xf
    v_dot2c_f32_bf16_dpp v153, v157, v106 row_newbcast:8 row_mask:0xf bank_mask:0xf
    v_dot2c_f32_bf16_dpp v154, v156, v107 row_newbcast:8 row_mask:0xf bank_mask:0xf
    v_dot2c_f32_bf16_dpp v155, v157, v107 row_newbcast:8 row_mask:0xf bank_mask:0xf
    global_load_dword v162, v167, s[24:25] sc1
    s_waitcnt vmcnt(7)
    v_dot2c_f32_bf16_dpp v148, v156, v108 row_newbcast:9 row_mask:0xf bank_mask:0xf
    v_dot2c_f32_bf16_dpp v149, v157, v108 row_newbcast:9 row_mask:0xf bank_mask:0xf
    v_dot2c_f32_bf16_dpp v150, v156, v109 row_newbcast:9 row_mask:0xf bank_mask:0xf
    v_dot2c_f32_bf16_dpp v151, v157, v109 row_newbcast:9 row_mask:0xf bank_mask:0xf
    v_dot2c_f32_bf16_dpp v152, v156, v110 row_newbcast:9 row_mask:0xf bank_mask:0xf
    v_dot2c_f32_bf16_dpp v153, v157, v110 row_newbcast:9 row_mask:0xf bank_mask:0xf
    v_dot2c_f32_bf16_dpp v154, v156, v111 row_newbcast:9 row_mask:0xf bank_mask:0xf
    v_dot2c_f32_bf16_dpp v155, v157, v111 row_newbcast:9 row_mask:0xf bank_mask:0xf
    s_waitcnt vmcnt(6)
    v_dot2c_f32_bf16_dpp v148, v156, v112 row_newbcast:10 row_mask:0xf bank_mask:0xf
    v_dot2c_f32_bf16_dpp v149, v157, v112 row_newbcast:10 row_mask:0xf bank_mask:0xf
    v_dot2c_f32_bf16_dpp v150, v156, v113 row_newbcast:10 row_mask:0xf bank_mask:0xf
    v_dot2c_f32_bf16_dpp v151, v157, v113 row_newbcast:10 row_mask:0xf bank_mask:0xf
    v_dot2c_f32_bf16_dpp v152, v156, v114 row_newbcast:10 row_mask:0xf bank_mask:0xf
    v_dot2c_f32_bf16_dpp v153, v157, v114 row_newbcast:10 row_mask:0xf bank_mask:0xf
    v_dot2c_f32_bf16_dpp v154, v156, v115 row_newbcast:10 row_mask:0xf bank_mask:0xf
    v_dot2c_f32_bf16_dpp v155, v157, v115 row_newbcast:10 row_mask:0xf bank_mask:0xf
    s_waitcnt vmcnt(5)
    v_dot2c_f32_bf16_dpp v148, v156, v116 row_newbcast:11 row_mask:0xf bank_mask:0xf
    v_dot2c_f32_bf16_dpp v149, v157, v116 row_newbcast:11 row_mask:0xf bank_mask:0xf
    v_dot2c_f32_bf16_dpp v150, v156, v117 row_newbcast:11 row_mask:0xf bank_mask:0xf
    v_dot2c_f32_bf16_dpp v151, v157, v117 row_newbcast:11 row_mask:0xf bank_mask:0xf
    v_dot2c_f32_bf16_dpp v152, v156, v118 row_newbcast:11 row_mask:0xf bank_mask:0xf
    v_dot2c_f32_bf16_dpp v153, v157, v118 row_newbcast:11 row_mask:0xf bank_mask:0xf
    v_dot2c_f32_bf16_dpp v154, v156, v119 row_newbcast:11 row_mask:0xf bank_mask:0xf
    v_dot2c_f32_bf16_dpp v155, v157, v119 row_newbcast:11 row_mask:0xf bank_mask:0xf
    s_waitcnt vmcnt(4)
    v_dot2c_f32_bf16_dpp v148, v156, v120 row_newbcast:12 row_mask:0xf bank_mask:0xf
    v_dot2c_f32_bf16_dpp v149, v157, v120 row_newbcast:12 row_mask:0xf bank_mask:0xf
    v_dot2c_f32_bf16_dpp v150, v156, v121 row_newbcast:12 row_mask:0xf bank_mask:0xf
    v_dot2c_f32_bf16_dpp v151, v157, v121 row_newbcast:12 row_mask:0xf bank_mask:0xf
    v_dot2c_f32_bf16_dpp v152, v156, v122 row_newbcast:12 row_mask:0xf bank_mask:0xf
    v_dot2c_f32_bf16_dpp v153, v157, v122 row_newbcast:12 row_mask:0xf bank_mask:0xf
    v_dot2c_f32_bf16_dpp v154, v156, v123 row_newbcast:12 row_mask:0xf bank_mask:0xf
    v_dot2c_f32_bf16_dpp v155, v157, v123 row_newbcast:12 row_mask:0xf bank_mask:0xf
    s_waitcnt vmcnt(3)
    v_dot2c_f32_bf16_dpp v148, v156, v124 row_newbcast:13 row_mask:0xf bank_mask:0xf
    v_dot2c_f32_bf16_dpp v149, v157, v124 row_newbcast:13 row_mask:0xf bank_mask:0xf
    v_dot2c_f32_bf16_dpp v150, v156, v125 row_newbcast:13 row_mask:0xf bank_mask:0xf
    v_dot2c_f32_bf16_dpp v151, v157, v125 row_newbcast:13 row_mask:0xf bank_mask:0xf
    v_dot2c_f32_bf16_dpp v152, v156, v126 row_newbcast:13 row_mask:0xf bank_mask:0xf
    v_dot2c_f32_bf16_dpp v153, v157, v126 row_newbcast:13 row_mask:0xf bank_mask:0xf
    v_dot2c_f32_bf16_dpp v154, v156, v127 row_newbcast:13 row_mask:0xf bank_mask:0xf
    v_dot2c_f32_bf16_dpp v155, v157, v127 row_newbcast:13 row_mask:0xf bank_mask:0xf
    s_waitcnt vmcnt(2)
    v_dot2c_f32_bf16_dpp v148, v156, v128 row_newbcast:14 row_mask:0xf bank_mask:0xf
    v_dot2c_f32_bf16_dpp v149, v157, v128 row_newbcast:14 row_mask:0xf bank_mask:0xf
    v_dot2c_f32_bf16_dpp v150, v156, v129 row_newbcast:14 row_mask:0xf bank_mask:0xf
    v_dot2c_f32_bf16_dpp v151, v157, v129 row_newbcast:14 row_mask:0xf bank_mask:0xf
    v_dot2c_f32_bf16_dpp v152, v156, v130 row_newbcast:14 row_mask:0xf bank_mask:0xf
    v_dot2c_f32_bf16_dpp v153, v157, v130 row_newbcast:14 row_mask:0xf bank_mask:0xf
    v_dot2c_f32_bf16_dpp v154, v156, v131 row_newbcast:14 row_mask:0xf bank_mask:0xf
    v_dot2c_f32_bf16_dpp v155, v157, v131 row_newbcast:14 row_mask:0xf bank_mask:0xf
    s_waitcnt vmcnt(1)
    v_dot2c_f32_bf16_dpp v148, v156, v132 row_newbcast:15 row_mask:0xf bank_mask:0xf
    v_dot2c_f32_bf16_dpp v149, v157, v132 row_newbcast:15 row_mask:0xf bank_mask:0xf
    v_dot2c_f32_bf16_dpp v150, v156, v133 row_newbcast:15 row_mask:0xf bank_mask:0xf
    v_dot2c_f32_bf16_dpp v151, v157, v133 row_newbcast:15 row_mask:0xf bank_mask:0xf
    v_dot2c_f32_bf16_dpp v152, v156, v134 row_newbcast:15 row_mask:0xf bank_mask:0xf
    v_dot2c_f32_bf16_dpp v153, v157, v134 row_newbcast:15 row_mask:0xf bank_mask:0xf
    v_dot2c_f32_bf16_dpp v154, v156, v135 row_newbcast:15 row_mask:0xf bank_mask:0xf
    v_dot2c_f32_bf16_dpp v155, v157, v135 row_newbcast:15 row_mask:0xf bank_mask:0xf
    v_permlane32_swap_b32 v140, v144
    v_permlane32_swap_b32 v141, v145
    v_permlane32_swap_b32 v142, v146
    v_permlane32_swap_b32 v143, v147
    v_add_f32 v140, v140, v144
    v_add_f32 v141, v141, v145
    v_add_f32 v142, v142, v146
    v_add_f32 v143, v143, v147
    s_nop 0
    v_permlane16_swap_b32 v140, v142
    v_permlane16_swap_b32 v141, v143
    v_add_f32 v140, v140, v142
    v_add_f32 v141, v141, v143
    v_permlane32_swap_b32 v148, v152
    v_permlane32_swap_b32 v149, v153
    v_permlane32_swap_b32 v150, v154
    v_permlane32_swap_b32 v151, v155
    v_add_f32 v148, v148, v152
    v_add_f32 v149, v149, v153
    v_add_f32 v150, v150, v154
    v_add_f32 v151, v151, v155
    s_nop 0
    v_permlane16_swap_b32 v148, v150
    v_permlane16_swap_b32 v149, v151
    v_add_f32 v148, v148, v150
    v_add_f32 v149, v149, v151
    s_mov_b32 s45, 262144
    s_branch L_gwchk
L_gw0:
    global_load_dword v162, v167, s[24:25] sc1
L_gwchk:
    s_waitcnt vmcnt(0)
    v_readlane_b32 s55, v162, s59
    s_nop 0
    s_cmp_lg_u32 s55, 0
    s_cbranch_scc1 L_gwok0
    s_sub_u32 s45, s45, 1
    s_cbranch_scc0 L_gw0
L_gwok0:
    s_bfe_u32 s40, s55, 0x30001
    s_cmp_eq_u32 s40, s31
    s_cselect_b32 s56, 1, 0
    v_lshrrev_b32 v4, 1, v162
    v_sub_u32 v4, v4, v0
    v_and_b32 v4, 7, v4
    v_cmp_ne_u32 s[46:47], 0, v162
    v_readlane_b32 s40, v4, s59
    s_nop 1
    v_cmp_ne_u32 vcc, s40, v4
    s_nop 0
    s_and_b64 s[46:47], s[46:47], vcc
    s_cselect_b32 s56, 0, s56
    s_xor_b32 s57, s56, 1
    s_mov_b32 s53, 0xffffff00
    v_and_b32 v4, 1, v3
    v_lshlrev_b32 v4, 4, v4
    v_lshrrev_b32 v4, v4, s55
    v_and_b32 v5, 0xff, v4
    v_bfe_u32 v4, v4, 8, 8
    v_and_b32 v140, -2, v140
    v_or_b32 v140, s57, v140
    v_add_u32 v148, 0x80, v148
    v_add_u32 v149, 0x80, v149
    v_and_or_b32 v142, v148, s53, v5
    v_and_or_b32 v143, v149, s53, v4
    v_lshl_add_u32 v4, v2, 2, v3
    s_lshl_b32 s40, s52, 10
    v_lshl_add_u32 v165, v4, 4, s40
    s_cmp_lg_u32 s56, 0
    s_cbranch_scc1 L_loc1
    global_store_dwordx4 v165, v[140:143], s[26:27] sc1
    s_branch L_pub1
L_loc1:
    global_store_dwordx4 v165, v[140:143], s[26:27]
L_pub1:
    s_mov_b32 s45, 2097152
L_gw:
    ds_read_b32 v8, v7 offset:8
    s_waitcnt lgkmcnt(0)
    v_readfirstlane_b32 s46, v8
    s_nop 0
    s_cmp_lg_u32 s46, 0
    s_cbranch_scc1 L_gwok
    s_sleep 1
    s_sub_u32 s45, s45, 1
    s_cbranch_scc0 L_gw
L_gwok:
    s_lshl_b32 s40, s28, 13
    v_lshl_add_u32 v40, v0, 4, s40
    v_add_u32 v41, 4096, v40
    v_and_b32 v6, 7, v0
    v_and_b32 v4, 1, v0
    v_lshlrev_b32 v4, 4, v4
    v_lshrrev_b32 v158, v4, s55
    v_lshrrev_b32 v159, 8, v158
    s_mov_b32 s45, 262144
L_g1:
    s_cmp_lg_u32 s56, 0
    s_cbranch_scc1 L_loc2
    global_load_dwordx4 v[8:11], v40, s[26:27] offset:0 sc1
    global_load_dwordx4 v[12:15], v40, s[26:27] offset:1024 sc1
    global_load_dwordx4 v[16:19], v40, s[26:27] offset:2048 sc1
    global_load_dwordx4 v[20:23], v40, s[26:27] offset:3072 sc1
    global_load_dwordx4 v[24:27], v41, s[26:27] offset:0 sc1
    global_load_dwordx4 v[28:31], v41, s[26:27] offset:1024 sc1
    global_load_dwordx4 v[32:35], v41, s[26:27] offset:2048 sc1
    global_load_dwordx4 v[36:39], v41, s[26:27] offset:3072 sc1
    s_branch L_pub2
L_loc2:
    global_load_dwordx4 v[8:11], v40, s[26:27] offset:0 sc1 nt
    global_load_dwordx4 v[12:15], v40, s[26:27] offset:1024 sc1 nt
    global_load_dwordx4 v[16:19], v40, s[26:27] offset:2048 sc1 nt
    global_load_dwordx4 v[20:23], v40, s[26:27] offset:3072 sc1 nt
    global_load_dwordx4 v[24:27], v41, s[26:27] offset:0 sc1 nt
    global_load_dwordx4 v[28:31], v41, s[26:27] offset:1024 sc1 nt
    global_load_dwordx4 v[32:35], v41, s[26:27] offset:2048 sc1 nt
    global_load_dwordx4 v[36:39], v41, s[26:27] offset:3072 sc1 nt
L_pub2:
    s_waitcnt vmcnt(7)
    v_xor_b32 v44, v158, v10
    v_xor_b32 v45, v159, v11
    s_waitcnt vmcnt(6)
    v_bitop3_b32 v44, v158, v14, v44 bitop3:0xbe
    v_bitop3_b32 v45, v159, v15, v45 bitop3:0xbe
    s_waitcnt vmcnt(5)
    v_bitop3_b32 v44, v158, v18, v44 bitop3:0xbe
    v_bitop3_b32 v45, v159, v19, v45 bitop3:0xbe
    s_waitcnt vmcnt(4)
    v_bitop3_b32 v44, v158, v22, v44 bitop3:0xbe
    v_bitop3_b32 v45, v159, v23, v45 bitop3:0xbe
    s_waitcnt vmcnt(3)
    v_bitop3_b32 v44, v158, v26, v44 bitop3:0xbe
    v_bitop3_b32 v45, v159, v27, v45 bitop3:0xbe
    s_waitcnt vmcnt(2)
    v_bitop3_b32 v44, v158, v30, v44 bitop3:0xbe
    v_bitop3_b32 v45, v159, v31, v45 bitop3:0xbe
    s_waitcnt vmcnt(1)
    v_bitop3_b32 v44, v158, v34, v44 bitop3:0xbe
    v_bitop3_b32 v45, v159, v35, v45 bitop3:0xbe
    s_waitcnt vmcnt(0)
    v_bitop3_b32 v44, v158, v38, v44 bitop3:0xbe
    v_bitop3_b32 v45, v159, v39, v45 bitop3:0xbe
    v_or_b32 v44, v44, v45
    v_and_b32 v44, 0xff, v44
    v_cmp_ne_u32 vcc, 0, v44
    s_nop 0
    s_cbranch_vccz L_g1_ok
    s_sub_u32 s45, s45, 1
    s_cbranch_scc0 L_g1
L_g1_ok:
    v_or3_b32 v44, v8, v12, v16
    v_or3_b32 v45, v20, v24, v28
    v_or3_b32 v44, v44, v32, v36
    v_or_b32 v44, v44, v45
    v_and_b32 v44, s56, v44
    v_cmp_ne_u32 vcc, 0, v44
    s_nop 0
    s_cbranch_vccz L_g1_same
    s_mov_b32 s56, 0
    global_store_dwordx4 v165, v[140:143], s[26:27] sc1
L_g1_same:
    v_and_b32 v8, -2, v8
    v_and_b32 v12, -2, v12
    v_and_b32 v16, -2, v16
    v_and_b32 v20, -2, v20
    v_and_b32 v24, -2, v24
    v_and_b32 v28, -2, v28
    v_and_b32 v32, -2, v32
    v_and_b32 v36, -2, v36
    v_add_f32 v8, v8, v12
    v_add_f32 v9, v9, v13
    v_add_f32 v8, v8, v16
    v_add_f32 v9, v9, v17
    v_add_f32 v8, v8, v20
    v_add_f32 v9, v9, v21
    v_add_f32 v8, v8, v24
    v_add_f32 v9, v9, v25
    v_add_f32 v8, v8, v28
    v_add_f32 v9, v9, v29
    v_add_f32 v8, v8, v32
    v_add_f32 v9, v9, v33
    v_add_f32 v8, v8, v36
    v_add_f32 v9, v9, v37
    v_cvt_pk_bf16_f32 v12, v8, v9
    v_lshlrev_b32 v4, 2, v0
    ds_write_b32 v4, v12 offset:28736
    v_mov_b32 v5, 1
    ds_write_b32 v7, v5
    v_and_b32 v10, s53, v10
    v_and_b32 v11, s53, v11
    v_and_b32 v14, s53, v14
    v_and_b32 v15, s53, v15
    v_and_b32 v18, s53, v18
    v_and_b32 v19, s53, v19
    v_and_b32 v22, s53, v22
    v_and_b32 v23, s53, v23
    v_and_b32 v26, s53, v26
    v_and_b32 v27, s53, v27
    v_and_b32 v30, s53, v30
    v_and_b32 v31, s53, v31
    v_and_b32 v34, s53, v34
    v_and_b32 v35, s53, v35
    v_and_b32 v38, s53, v38
    v_and_b32 v39, s53, v39
    v_add_f32 v10, v10, v14
    v_add_f32 v11, v11, v15
    v_add_f32 v10, v10, v18
    v_add_f32 v11, v11, v19
    v_add_f32 v10, v10, v22
    v_add_f32 v11, v11, v23
    v_add_f32 v10, v10, v26
    v_add_f32 v11, v11, v27
    v_add_f32 v10, v10, v30
    v_add_f32 v11, v11, v31
    v_add_f32 v10, v10, v34
    v_add_f32 v11, v11, v35
    v_add_f32 v10, v10, v38
    v_add_f32 v11, v11, v39
    v_cvt_pk_bf16_f32 v12, v10, v11
    s_nop 1
    v_mov_b32_dpp v13, v12 row_shl:4 row_mask:0xf bank_mask:0xf
    v_lshlrev_b32 v14, 16, v12
    v_and_b32 v15, s48, v12
    s_mov_b32 s40, 0x3d372713
    s_mov_b32 s41, 0xc0135761
    v_mul_f32 v16, v14, v14
    v_mul_f32 v17, v15, v15
    v_mul_f32 v16, v16, v14
    v_mul_f32 v17, v17, v15
    v_fma_f32 v16, v16, s40, v14
    v_fma_f32 v17, v17, s40, v15
    v_mul_f32 v16, s41, v16
    v_mul_f32 v17, s41, v17
    v_exp_f32 v16, v16
    v_exp_f32 v17, v17
    v_add_f32 v16, 1.0, v16
    v_add_f32 v17, 1.0, v17
    v_rcp_f32 v16, v16
    v_rcp_f32 v17, v17
    v_mul_f32 v14, v14, v16
    v_mul_f32 v15, v15, v17
    v_cvt_pk_bf16_f32 v14, v14, v15
    v_lshlrev_b32 v16, 16, v13
    v_and_b32 v17, s48, v13
    v_and_b32 v15, s48, v14
    v_lshlrev_b32 v14, 16, v14
    v_mul_f32 v14, v14, v16
    v_mul_f32 v15, v15, v17
    v_cvt_pk_bf16_f32 v14, v14, v15
    v_lshrrev_b32 v5, 3, v0
    v_cmp_gt_u32 vcc, s51, v5
    s_nop 1
    v_cndmask_b32 v14, 0, v14, vcc
    v_and_b32 v4, 3, v0
    v_lshl_add_u32 v4, v5, 2, v4
    v_lshlrev_b32 v4, 2, v4
    s_mov_b32 exec_lo, 0x0f0f0f0f
    s_mov_b32 exec_hi, 0x0f0f0f0f
    ds_write_b32 v4, v14 offset:28992
    s_mov_b64 exec, -1
    v_lshlrev_b32 v5, 4, v3
    ds_read_b128 v[144:147], v5 offset:28992
    ds_read_b128 v[148:151], v5 offset:29056
    v_mov_b32 v140, 0
    v_mov_b32 v141, 0
    v_mov_b32 v142, 0
    v_mov_b32 v143, 0
    ds_write_b128 v1, v[140:143] offset:22528
    ds_write_b128 v1, v[140:143] offset:23552
    v_lshlrev_b32 v160, 10, v3
    v_lshrrev_b32 v5, 2, v2
    v_lshl_add_u32 v160, v5, 7, v160
    v_and_b32 v5, 3, v0
    v_lshl_add_u32 v160, v5, 3, v160
    v_bfe_u32 v5, v0, 3, 2
    v_lshl_add_u32 v160, v5, 5, v160
    v_xor_b32 v162, 32, v160
    v_xor_b32 v163, 64, v160
    v_xor_b32 v164, 0x60, v160
    s_lshl_b32 s40, s50, 13
    s_lshl_b32 s41, s29, 7
    s_add_u32 s40, s40, s41
    s_add_u32 s32, s20, s40
    s_addc_u32 s33, s21, 0
    s_and_b32 s33, s33, 0xffff
    s_sub_u32 s34, 1409024, s40
    s_lshl_b32 s40, s28, 17
    s_add_u32 s40, s40, s41
    s_add_u32 s36, s12, s40
    s_addc_u32 s37, s13, 0
    s_and_b32 s37, s37, 0xffff
    s_sub_u32 s38, 4194304, s40
    s_mov_b32 s39, 0x20000
    v_lshrrev_b32 v152, 3, v0
    v_lshlrev_b32 v152, 10, v152
    v_lshl_add_u32 v152, v6, 4, v152
    v_and_b32 v5, 16, v0
    v_lshlrev_b32 v5, 1, v5
    v_xor_b32 v152, v5, v152
    v_xor_b32 v153, 64, v152
    s_cmp_eq_u32 s51, 6
    s_cselect_b32 s40, 0, 2146435072
    v_add_u32 v8, s40, v153
    s_movk_i32 s42, 0x2000
    s_mov_b32 s41, 0
    s_mov_b32 m0, 16384
    s_waitcnt lgkmcnt(0)
    buffer_load_dwordx4 v152, s[32:35], s41 offen nt lds
    s_mov_b32 m0, 17408
    s_add_u32 s41, s41, s42
    buffer_load_dwordx4 v153, s[32:35], s41 offen nt lds
    s_mov_b32 m0, 18432
    s_add_u32 s41, s41, s42
    buffer_load_dwordx4 v152, s[32:35], s41 offen nt lds
    s_mov_b32 m0, 19456
    s_add_u32 s41, s41, s42
    buffer_load_dwordx4 v153, s[32:35], s41 offen nt lds
    s_mov_b32 m0, 20480
    s_add_u32 s41, s41, s42
    buffer_load_dwordx4 v152, s[32:35], s41 offen nt lds
    s_mov_b32 m0, 21504
    s_add_u32 s41, s41, s42
    buffer_load_dwordx4 v8, s[32:35], s41 offen nt lds
    s_lshl_b32 s40, s29, 14
    s_lshl_b32 s41, s28, 7
    s_add_u32 s40, s40, s41
    s_add_u32 s40, s40, 524288
    v_lshlrev_b32 v161, 12, v3
    v_lshl_add_u32 v161, v2, 3, v161
    v_add_u32 v161, s40, v161
    v_and_b32 v158, 0xff, v158
    v_and_b32 v159, 0xff, v159
    s_and_b32 s42, s28, 3
    s_lshl_b32 s40, s29, 6
    s_lshl_b32 s41, s42, 4
    s_add_u32 s40, s40, s41
    v_lshrrev_b32 v4, 5, v0
    v_lshl_add_u32 v4, v6, 1, v4
    v_add_u32 v4, s40, v4
    v_lshlrev_b32 v156, 1, v4
    s_lshl_b32 s40, s29, 14
    s_lshl_b32 s41, s42, 12
    s_add_u32 s40, s40, s41
    s_add_u32 s40, s40, 524288
    v_lshl_add_u32 v155, v0, 4, s40
    s_lshr_b32 s58, s28, 3
    s_cmp_eq_u32 s58, 0
    s_cbranch_scc0 L_nored1
    s_mov_b32 s45, 262144
    v_lshrrev_b32 v4, 3, v0
    v_lshlrev_b32 v4, 5, v4
L_f2:
    global_load_dword v88, v4, s[24:25] sc1
    s_waitcnt vmcnt(0)
    v_cmp_eq_u32 vcc, 0, v88
    s_nop 0
    s_cbranch_vccz L_f2ok
    s_sleep 4
    s_sub_u32 s45, s45, 1
    s_cbranch_scc0 L_f2
L_f2ok:
    v_lshrrev_b32 v89, 8, v88
    v_lshrrev_b32 v90, 16, v88
    v_lshrrev_b32 v91, 24, v88
    global_load_ushort v154, v156, s[4:5]
    s_waitcnt vmcnt(0)
    v_lshlrev_b32 v154, 16, v154
L_nored1:
    v_lshlrev_b32 v4, 3, v0
    v_mov_b32 v5, 0
    s_mov_b32 s49, 0x3fb8aa3b
    s_lshl_b32 s40, s28, 12
    s_add_u32 s40, s40, 327680
    v_lshl_add_u32 v6, v0, 4, s40
    v_and_b32 v8, 1, v0
    v_lshlrev_b32 v166, 3, v8
    v_bfe_u32 v8, v0, 1, 1
    v_lshl_add_u32 v166, v8, 10, v166
    v_bfe_u32 v8, v0, 2, 2
    v_lshl_add_u32 v166, v8, 8, v166
    v_bfe_u32 v8, v0, 4, 1
    v_lshl_add_u32 v166, v8, 11, v166
    v_lshrrev_b32 v8, 5, v0
    v_lshl_add_u32 v166, v8, 7, v166
    s_lshl_b32 s41, s29, 4
    s_add_u32 s41, s40, s41
    v_add_u32 v166, s41, v166
    s_cmp_lg_u32 s56, 0
    s_cbranch_scc1 L_x2loc
    v_and_b32 v8, 7, v0
    v_lshlrev_b32 v6, 7, v8
    v_bfe_u32 v8, v0, 3, 1
    v_lshl_add_u32 v6, v8, 6, v6
    v_lshl_add_u32 v6, v3, 4, v6
    v_add_u32 v6, s40, v6
    v_and_b32 v8, 1, v0
    v_lshlrev_b32 v166, 3, v8
    v_bfe_u32 v8, v0, 1, 1
    v_lshl_add_u32 v166, v8, 10, v166
    v_bfe_u32 v8, v0, 2, 2
    v_lshl_add_u32 v166, v8, 4, v166
    v_bfe_u32 v8, v0, 4, 1
    v_lshl_add_u32 v166, v8, 11, v166
    v_lshrrev_b32 v8, 5, v0
    v_lshl_add_u32 v166, v8, 6, v166
    s_lshl_b32 s41, s29, 7
    s_add_u32 s41, s40, s41
    v_add_u32 v166, s41, v166
L_x2loc:
    v_lshl_add_u32 v157, v3, 2, v2
    v_and_b32 v157, 7, v157
    s_lshl_b32 s40, s28, 7
    s_add_u32 s40, s40, 294912
    v_lshl_add_u32 v157, v157, 4, s40
    s_lshl_b32 s41, s29, 4
    s_add_u32 s40, s40, s41
    v_mov_b32 v167, s40
    v_mov_b32 v139, s55
    v_mov_b32 v141, s55
    v_mov_b32 v143, s55
    s_waitcnt vmcnt(0)
    ds_read_b64_tr_b16 v[40:41], v160 offset:16384
    ds_read_b64_tr_b16 v[42:43], v160 offset:16896
    ds_read_b64_tr_b16 v[44:45], v162 offset:16384
    ds_read_b64_tr_b16 v[46:47], v162 offset:16896
    ds_read_b64_tr_b16 v[48:49], v163 offset:16384
    ds_read_b64_tr_b16 v[50:51], v163 offset:16896
    ds_read_b64_tr_b16 v[52:53], v164 offset:16384
    ds_read_b64_tr_b16 v[54:55], v164 offset:16896
    ds_read_b64_tr_b16 v[56:57], v160 offset:20480
    ds_read_b64_tr_b16 v[58:59], v160 offset:20992
    ds_read_b64_tr_b16 v[60:61], v162 offset:20480
    ds_read_b64_tr_b16 v[62:63], v162 offset:20992
    ds_read_b64_tr_b16 v[64:65], v163 offset:20480
    ds_read_b64_tr_b16 v[66:67], v163 offset:20992
    ds_read_b64_tr_b16 v[68:69], v164 offset:20480
    ds_read_b64_tr_b16 v[70:71], v164 offset:20992
    s_waitcnt lgkmcnt(0)
    v_mfma_f32_16x16x32_bf16 v[124:127], v[144:147], v[40:43], 0
    v_mfma_f32_16x16x32_bf16 v[128:131], v[144:147], v[44:47], 0
    v_mfma_f32_16x16x32_bf16 v[132:135], v[144:147], v[48:51], 0
    v_mfma_f32_16x16x32_bf16 v[136:139], v[144:147], v[52:55], 0
    v_mfma_f32_16x16x32_bf16 v[124:127], v[148:151], v[56:59], v[124:127]
    v_mfma_f32_16x16x32_bf16 v[128:131], v[148:151], v[60:63], v[128:131]
    v_mfma_f32_16x16x32_bf16 v[132:135], v[148:151], v[64:67], v[132:135]
    v_mfma_f32_16x16x32_bf16 v[136:139], v[148:151], v[68:71], v[136:139]
    s_nop 5
    v_mov_b32_dpp v124, v128 quad_perm:[0,1,2,3] row_mask:0x2 bank_mask:0xf
    s_nop 0
    v_mov_b32_dpp v132, v136 quad_perm:[0,1,2,3] row_mask:0x8 bank_mask:0xf
    s_nop 1
    v_mov_b32_dpp v124, v132 quad_perm:[0,1,2,3] row_mask:0xc bank_mask:0xf
    v_add_u32 v124, 0x80, v124
    v_and_or_b32 v145, v124, s53, v159
    v_mov_b32 v139, s55
    s_mov_b32 s45, 2097152
L_ml:
    ds_read_b32 v8, v7 offset:12
    s_waitcnt lgkmcnt(0)
    v_readfirstlane_b32 s46, v8
    s_nop 0
    s_cmp_ge_u32 s46, 8
    s_cbranch_scc1 L_mlok
    s_sleep 1
    s_sub_u32 s45, s45, 1
    s_cbranch_scc0 L_ml
L_mlok:
    ds_read_b128 v[120:123], v5 offset:28672
    ds_read_b128 v[124:127], v5 offset:28688
    ds_read_b128 v[128:131], v5 offset:28704
    ds_read_b128 v[132:135], v5 offset:28720
    s_waitcnt lgkmcnt(0)
    v_max3_f32 v140, v120, v122, v124
    v_max3_f32 v142, v126, v128, v130
    v_max3_f32 v140, v140, v132, v134
    v_max_f32 v140, v140, v142
    v_sub_f32 v120, v120, v140
    v_sub_f32 v122, v122, v140
    v_sub_f32 v124, v124, v140
    v_sub_f32 v126, v126, v140
    v_sub_f32 v128, v128, v140
    v_sub_f32 v130, v130, v140
    v_sub_f32 v132, v132, v140
    v_sub_f32 v134, v134, v140
    v_mul_f32 v120, s49, v120
    v_mul_f32 v122, s49, v122
    v_mul_f32 v124, s49, v124
    v_mul_f32 v126, s49, v126
    v_mul_f32 v128, s49, v128
    v_mul_f32 v130, s49, v130
    v_mul_f32 v132, s49, v132
    v_mul_f32 v134, s49, v134
    v_exp_f32 v120, v120
    v_exp_f32 v122, v122
    v_exp_f32 v124, v124
    v_exp_f32 v126, v126
    v_exp_f32 v128, v128
    v_exp_f32 v130, v130
    v_exp_f32 v132, v132
    v_exp_f32 v134, v134
    v_mul_f32 v142, v120, v121
    v_mul_f32 v108, v122, v123
    v_fmac_f32 v142, v124, v125
    v_fmac_f32 v108, v126, v127
    v_fmac_f32 v142, v128, v129
    v_fmac_f32 v108, v130, v131
    v_fmac_f32 v142, v132, v133
    v_fmac_f32 v108, v134, v135
    v_add_f32 v142, v142, v108
    s_cmp_lg_u32 s56, 0
    s_cbranch_scc1 L_loc3
    s_mov_b64 exec, 1
    global_store_dwordx4 v167, v[140:143], s[26:27] sc1
    s_mov_b64 exec, -1
    s_branch L_pub3
L_loc3:
    s_mov_b64 exec, 1
    global_store_dwordx4 v167, v[140:143], s[26:27]
    s_mov_b64 exec, -1
L_pub3:
    s_mov_b32 s45, 2097152
L_wo:
    ds_read_b32 v8, v7 offset:4
    s_waitcnt lgkmcnt(0)
    v_readfirstlane_b32 s46, v8
    s_nop 0
    s_cmp_ge_u32 s46, 8
    s_cbranch_scc1 L_wook
    s_sleep 1
    s_sub_u32 s45, s45, 1
    s_cbranch_scc0 L_wo
L_wook:
    v_mov_b32 v167, 16
    s_cmp_lg_u32 s58, 0
    s_cbranch_scc1 L_nocand
    global_load_dword v167, v167, s[24:25] sc1
L_nocand:
    s_movk_i32 s42, 0x2000
    s_mov_b32 m0, 8192
    s_mov_b32 s41, 65536
    buffer_load_dwordx4 v152, s[36:39], s41 offen nt lds
    s_mov_b32 m0, 9216
    s_add_u32 s41, s41, s42
    buffer_load_dwordx4 v153, s[36:39], s41 offen nt lds
    s_mov_b32 m0, 10240
    s_add_u32 s41, s41, s42
    buffer_load_dwordx4 v152, s[36:39], s41 offen nt lds
    s_mov_b32 m0, 11264
    s_add_u32 s41, s41, s42
    buffer_load_dwordx4 v153, s[36:39], s41 offen nt lds
    s_mov_b32 m0, 12288
    s_add_u32 s41, s41, s42
    buffer_load_dwordx4 v152, s[36:39], s41 offen nt lds
    s_mov_b32 m0, 13312
    s_add_u32 s41, s41, s42
    buffer_load_dwordx4 v153, s[36:39], s41 offen nt lds
    s_mov_b32 m0, 14336
    s_add_u32 s41, s41, s42
    buffer_load_dwordx4 v152, s[36:39], s41 offen nt lds
    s_mov_b32 m0, 15360
    s_add_u32 s41, s41, s42
    buffer_load_dwordx4 v153, s[36:39], s41 offen nt lds
    s_mov_b32 m0, 0
    s_mov_b32 s41, 0
    buffer_load_dwordx4 v152, s[36:39], s41 offen nt lds
    s_mov_b32 m0, 1024
    s_add_u32 s41, s41, s42
    buffer_load_dwordx4 v153, s[36:39], s41 offen nt lds
    s_mov_b32 m0, 2048
    s_add_u32 s41, s41, s42
    buffer_load_dwordx4 v152, s[36:39], s41 offen nt lds
    s_mov_b32 m0, 3072
    s_add_u32 s41, s41, s42
    buffer_load_dwordx4 v153, s[36:39], s41 offen nt lds
    s_mov_b32 m0, 4096
    s_add_u32 s41, s41, s42
    buffer_load_dwordx4 v152, s[36:39], s41 offen nt lds
    s_mov_b32 m0, 5120
    s_add_u32 s41, s41, s42
    buffer_load_dwordx4 v153, s[36:39], s41 offen nt lds
    s_mov_b32 m0, 6144
    s_add_u32 s41, s41, s42
    buffer_load_dwordx4 v152, s[36:39], s41 offen nt lds
    s_mov_b32 m0, 7168
    s_add_u32 s41, s41, s42
    buffer_load_dwordx4 v153, s[36:39], s41 offen nt lds
    s_barrier
    ds_read_b64 v[72:73], v4 offset:24576
    ds_read_b64 v[74:75], v4 offset:25088
    ds_read_b64 v[76:77], v4 offset:25600
    ds_read_b64 v[78:79], v4 offset:26112
    ds_read_b64 v[80:81], v4 offset:26624
    ds_read_b64 v[82:83], v4 offset:27136
    ds_read_b64 v[84:85], v4 offset:27648
    ds_read_b64 v[86:87], v4 offset:28160
    s_waitcnt lgkmcnt(6)
    v_mul_f32 v104, v120, v72
    v_mul_f32 v105, v120, v73
    v_mul_f32 v106, v122, v74
    v_mul_f32 v107, v122, v75
    s_waitcnt lgkmcnt(4)
    v_fmac_f32 v104, v124, v76
    v_fmac_f32 v105, v124, v77
    v_fmac_f32 v106, v126, v78
    v_fmac_f32 v107, v126, v79
    s_waitcnt lgkmcnt(2)
    v_fmac_f32 v104, v128, v80
    v_fmac_f32 v105, v128, v81
    v_fmac_f32 v106, v130, v82
    v_fmac_f32 v107, v130, v83
    s_waitcnt lgkmcnt(0)
    v_fmac_f32 v104, v132, v84
    v_fmac_f32 v105, v132, v85
    v_fmac_f32 v106, v134, v86
    v_fmac_f32 v107, v134, v87
    v_add_f32 v104, v104, v106
    v_add_f32 v105, v105, v107
    v_cvt_pk_bf16_f32 v138, v104, v105
    s_cmp_lg_u32 s56, 0
    s_cbranch_scc1 L_loc4
    global_store_dwordx2 v166, v[138:139], s[26:27] sc1
    s_branch L_pub4
L_loc4:
    global_store_dwordx2 v166, v[138:139], s[26:27]
L_pub4:
    s_cmp_lg_u32 s56, 0
    s_cbranch_scc1 L_loc5
    global_load_dwordx4 v[120:123], v157, s[26:27] sc1
    global_load_dwordx4 v[104:107], v6, s[26:27] offset:0 sc1
    global_load_dwordx4 v[108:111], v6, s[26:27] offset:1024 sc1
    global_load_dwordx4 v[112:115], v6, s[26:27] offset:2048 sc1
    global_load_dwordx4 v[116:119], v6, s[26:27] offset:3072 sc1
    s_branch L_pub5
L_loc5:
    global_load_dwordx4 v[120:123], v157, s[26:27] sc1 nt
    global_load_dwordx4 v[104:107], v6, s[26:27] offset:0 sc1 nt
    global_load_dwordx4 v[108:111], v6, s[26:27] offset:1024 sc1 nt
    global_load_dwordx4 v[112:115], v6, s[26:27] offset:2048 sc1 nt
    global_load_dwordx4 v[116:119], v6, s[26:27] offset:3072 sc1 nt
L_pub5:
    s_waitcnt vmcnt(14)
    ds_read_b64_tr_b16 v[40:41], v160 offset:8192
    ds_read_b64_tr_b16 v[42:43], v160 offset:8704
    ds_read_b64_tr_b16 v[44:45], v162 offset:8192
    ds_read_b64_tr_b16 v[46:47], v162 offset:8704
    ds_read_b64_tr_b16 v[48:49], v163 offset:8192
    ds_read_b64_tr_b16 v[50:51], v163 offset:8704
    ds_read_b64_tr_b16 v[52:53], v164 offset:8192
    ds_read_b64_tr_b16 v[54:55], v164 offset:8704
    ds_read_b64_tr_b16 v[56:57], v160 offset:12288
    ds_read_b64_tr_b16 v[58:59], v160 offset:12800
    ds_read_b64_tr_b16 v[60:61], v162 offset:12288
    ds_read_b64_tr_b16 v[62:63], v162 offset:12800
    ds_read_b64_tr_b16 v[64:65], v163 offset:12288
    ds_read_b64_tr_b16 v[66:67], v163 offset:12800
    ds_read_b64_tr_b16 v[68:69], v164 offset:12288
    ds_read_b64_tr_b16 v[70:71], v164 offset:12800
    s_waitcnt vmcnt(6)
    ds_read_b64_tr_b16 v[8:9], v160 offset:0
    ds_read_b64_tr_b16 v[10:11], v160 offset:512
    ds_read_b64_tr_b16 v[12:13], v162 offset:0
    ds_read_b64_tr_b16 v[14:15], v162 offset:512
    ds_read_b64_tr_b16 v[16:17], v163 offset:0
    ds_read_b64_tr_b16 v[18:19], v163 offset:512
    ds_read_b64_tr_b16 v[20:21], v164 offset:0
    ds_read_b64_tr_b16 v[22:23], v164 offset:512
    ds_read_b64_tr_b16 v[24:25], v160 offset:4096
    ds_read_b64_tr_b16 v[26:27], v160 offset:4608
    ds_read_b64_tr_b16 v[28:29], v162 offset:4096
    ds_read_b64_tr_b16 v[30:31], v162 offset:4608
    ds_read_b64_tr_b16 v[32:33], v163 offset:4096
    ds_read_b64_tr_b16 v[34:35], v163 offset:4608
    ds_read_b64_tr_b16 v[36:37], v164 offset:4096
    ds_read_b64_tr_b16 v[38:39], v164 offset:4608
    v_readfirstlane_b32 s46, v167
    s_and_b32 s40, s28, 3
    s_lshl_b32 s41, s40, 3
    v_readlane_b32 s41, v88, s41
    s_lshr_b32 s40, s40, 1
    s_lshr_b32 s47, s28, 2
    s_xor_b32 s40, s40, s47
    s_lshr_b32 s41, s41, 3
    s_xor_b32 s57, s41, s40
    s_mov_b32 s45, 262144
L_p1:
    s_cmp_lg_u32 s56, 0
    s_cbranch_scc1 L_loc6
    global_load_dwordx4 v[92:95], v157, s[26:27] sc1
    global_load_dwordx4 v[72:75], v6, s[26:27] offset:0 sc1
    global_load_dwordx4 v[76:79], v6, s[26:27] offset:1024 sc1
    global_load_dwordx4 v[80:83], v6, s[26:27] offset:2048 sc1
    global_load_dwordx4 v[84:87], v6, s[26:27] offset:3072 sc1
    s_branch L_pub6
L_loc6:
    global_load_dwordx4 v[92:95], v157, s[26:27] sc1 nt
    global_load_dwordx4 v[72:75], v6, s[26:27] offset:0 sc1 nt
    global_load_dwordx4 v[76:79], v6, s[26:27] offset:1024 sc1 nt
    global_load_dwordx4 v[80:83], v6, s[26:27] offset:2048 sc1 nt
    global_load_dwordx4 v[84:87], v6, s[26:27] offset:3072 sc1 nt
L_pub6:
    s_waitcnt vmcnt(5)
    v_xor_b32 v136, s55, v105
    v_xor_b32 v137, s55, v107
    v_bitop3_b32 v136, s55, v121, v136 bitop3:0xbe
    v_bitop3_b32 v137, s55, v123, v137 bitop3:0xbe
    v_bitop3_b32 v136, s55, v109, v136 bitop3:0xbe
    v_bitop3_b32 v137, s55, v111, v137 bitop3:0xbe
    v_bitop3_b32 v136, s55, v113, v136 bitop3:0xbe
    v_bitop3_b32 v137, s55, v115, v137 bitop3:0xbe
    v_bitop3_b32 v136, s55, v117, v136 bitop3:0xbe
    v_bitop3_b32 v137, s55, v119, v137 bitop3:0xbe
    v_or_b32 v136, v136, v137
    v_cmp_ne_u32 vcc, 0, v136
    s_nop 0
    s_cbranch_vccz L_p1ok0
    s_cmp_lg_u32 s56, 0
    s_cbranch_scc1 L_loc7
    global_load_dwordx4 v[120:123], v157, s[26:27] sc1
    global_load_dwordx4 v[104:107], v6, s[26:27] offset:0 sc1
    global_load_dwordx4 v[108:111], v6, s[26:27] offset:1024 sc1
    global_load_dwordx4 v[112:115], v6, s[26:27] offset:2048 sc1
    global_load_dwordx4 v[116:119], v6, s[26:27] offset:3072 sc1
    s_branch L_pub7
L_loc7:
    global_load_dwordx4 v[120:123], v157, s[26:27] sc1 nt
    global_load_dwordx4 v[104:107], v6, s[26:27] offset:0 sc1 nt
    global_load_dwordx4 v[108:111], v6, s[26:27] offset:1024 sc1 nt
    global_load_dwordx4 v[112:115], v6, s[26:27] offset:2048 sc1 nt
    global_load_dwordx4 v[116:119], v6, s[26:27] offset:3072 sc1 nt
L_pub7:
    s_waitcnt vmcnt(5)
    v_xor_b32 v136, s55, v73
    v_xor_b32 v137, s55, v75
    v_bitop3_b32 v136, s55, v93, v136 bitop3:0xbe
    v_bitop3_b32 v137, s55, v95, v137 bitop3:0xbe
    v_bitop3_b32 v136, s55, v77, v136 bitop3:0xbe
    v_bitop3_b32 v137, s55, v79, v137 bitop3:0xbe
    v_bitop3_b32 v136, s55, v81, v136 bitop3:0xbe
    v_bitop3_b32 v137, s55, v83, v137 bitop3:0xbe
    v_bitop3_b32 v136, s55, v85, v136 bitop3:0xbe
    v_bitop3_b32 v137, s55, v87, v137 bitop3:0xbe
    v_or_b32 v136, v136, v137
    v_cmp_ne_u32 vcc, 0, v136
    s_nop 0
    s_cbranch_vccz L_p1ok1
    s_sub_u32 s45, s45, 1
    s_cbranch_scc0 L_p1
L_p1ok1:
    v_mov_b32_dpp v96, v72 row_ror:8 row_mask:0xf bank_mask:0xf
    v_mov_b32_dpp v97, v74 row_ror:8 row_mask:0xf bank_mask:0xf
    v_mov_b32_dpp v98, v76 row_ror:8 row_mask:0xf bank_mask:0xf
    v_mov_b32_dpp v99, v78 row_ror:8 row_mask:0xf bank_mask:0xf
    s_waitcnt lgkmcnt(0)
    s_nop 0
    v_mfma_f32_16x16x32_bf16 v[124:127], v[96:99], v[40:43], 0
    v_mov_b32_dpp v100, v80 row_ror:8 row_mask:0xf bank_mask:0xf
    v_mov_b32_dpp v101, v82 row_ror:8 row_mask:0xf bank_mask:0xf
    v_mfma_f32_16x16x32_bf16 v[128:131], v[96:99], v[44:47], 0
    v_mov_b32_dpp v102, v84 row_ror:8 row_mask:0xf bank_mask:0xf
    v_mov_b32_dpp v103, v86 row_ror:8 row_mask:0xf bank_mask:0xf
    v_mfma_f32_16x16x32_bf16 v[132:135], v[96:99], v[48:51], 0
    v_mov_b32 v73, v74
    v_mov_b32 v74, v76
    v_mfma_f32_16x16x32_bf16 v[136:139], v[96:99], v[52:55], 0
    v_mov_b32 v75, v78
    v_max_f32_dpp v93, v92, v92 row_ror:4 row_mask:0xf bank_mask:0xf
    v_mfma_f32_16x16x32_bf16 v[124:127], v[100:103], v[56:59], v[124:127]
    v_mov_b32 v81, v82
    v_mov_b32 v82, v84
    v_mfma_f32_16x16x32_bf16 v[128:131], v[100:103], v[60:63], v[128:131]
    v_max_f32_dpp v93, v93, v93 row_ror:2 row_mask:0xf bank_mask:0xf
    v_mov_b32 v83, v86
    v_mfma_f32_16x16x32_bf16 v[132:135], v[100:103], v[64:67], v[132:135]
    v_max_f32_dpp v93, v93, v93 row_ror:1 row_mask:0xf bank_mask:0xf
    v_mfma_f32_16x16x32_bf16 v[136:139], v[100:103], v[68:71], v[136:139]
    v_sub_f32 v92, v92, v93
    v_mul_f32 v92, s49, v92
    v_mfma_f32_16x16x32_bf16 v[124:127], v[72:75], v[8:11], v[124:127]
    v_exp_f32 v92, v92
    v_mfma_f32_16x16x32_bf16 v[128:131], v[72:75], v[12:15], v[128:131]
    v_mul_f32 v94, v92, v94
    v_mfma_f32_16x16x32_bf16 v[132:135], v[72:75], v[16:19], v[132:135]
    s_nop 0
    v_add_f32_dpp v94, v94, v94 row_ror:4 row_mask:0xf bank_mask:0xf
    v_mfma_f32_16x16x32_bf16 v[136:139], v[72:75], v[20:23], v[136:139]
    s_nop 0
    v_add_f32_dpp v94, v94, v94 row_ror:2 row_mask:0xf bank_mask:0xf
    v_mfma_f32_16x16x32_bf16 v[124:127], v[80:83], v[24:27], v[124:127]
    s_nop 0
    v_add_f32_dpp v94, v94, v94 row_ror:1 row_mask:0xf bank_mask:0xf
    v_rcp_f32 v94, v94
    v_mfma_f32_16x16x32_bf16 v[128:131], v[80:83], v[28:31], v[128:131]
    v_mul_f32 v146, v92, v94
    v_mfma_f32_16x16x32_bf16 v[132:135], v[80:83], v[32:35], v[132:135]
    v_mfma_f32_16x16x32_bf16 v[136:139], v[80:83], v[36:39], v[136:139]
    s_branch L_p1done
L_p1ok0:
    v_mov_b32_dpp v96, v104 row_ror:8 row_mask:0xf bank_mask:0xf
    v_mov_b32_dpp v97, v106 row_ror:8 row_mask:0xf bank_mask:0xf
    v_mov_b32_dpp v98, v108 row_ror:8 row_mask:0xf bank_mask:0xf
    v_mov_b32_dpp v99, v110 row_ror:8 row_mask:0xf bank_mask:0xf
    s_waitcnt lgkmcnt(0)
    s_nop 0
    v_mfma_f32_16x16x32_bf16 v[124:127], v[96:99], v[40:43], 0
    v_mov_b32_dpp v100, v112 row_ror:8 row_mask:0xf bank_mask:0xf
    v_mov_b32_dpp v101, v114 row_ror:8 row_mask:0xf bank_mask:0xf
    v_mfma_f32_16x16x32_bf16 v[128:131], v[96:99], v[44:47], 0
    v_mov_b32_dpp v102, v116 row_ror:8 row_mask:0xf bank_mask:0xf
    v_mov_b32_dpp v103, v118 row_ror:8 row_mask:0xf bank_mask:0xf
    v_mfma_f32_16x16x32_bf16 v[132:135], v[96:99], v[48:51], 0
    v_mov_b32 v105, v106
    v_mov_b32 v106, v108
    v_mfma_f32_16x16x32_bf16 v[136:139], v[96:99], v[52:55], 0
    v_mov_b32 v107, v110
    v_max_f32_dpp v121, v120, v120 row_ror:4 row_mask:0xf bank_mask:0xf
    v_mfma_f32_16x16x32_bf16 v[124:127], v[100:103], v[56:59], v[124:127]
    v_mov_b32 v113, v114
    v_mov_b32 v114, v116
    v_mfma_f32_16x16x32_bf16 v[128:131], v[100:103], v[60:63], v[128:131]
    v_max_f32_dpp v121, v121, v121 row_ror:2 row_mask:0xf bank_mask:0xf
    v_mov_b32 v115, v118
    v_mfma_f32_16x16x32_bf16 v[132:135], v[100:103], v[64:67], v[132:135]
    v_max_f32_dpp v121, v121, v121 row_ror:1 row_mask:0xf bank_mask:0xf
    v_mfma_f32_16x16x32_bf16 v[136:139], v[100:103], v[68:71], v[136:139]
    v_sub_f32 v120, v120, v121
    v_mul_f32 v120, s49, v120
    v_mfma_f32_16x16x32_bf16 v[124:127], v[104:107], v[8:11], v[124:127]
    v_exp_f32 v120, v120
    v_mfma_f32_16x16x32_bf16 v[128:131], v[104:107], v[12:15], v[128:131]
    v_mul_f32 v122, v120, v122
    v_mfma_f32_16x16x32_bf16 v[132:135], v[104:107], v[16:19], v[132:135]
    s_nop 0
    v_add_f32_dpp v122, v122, v122 row_ror:4 row_mask:0xf bank_mask:0xf
    v_mfma_f32_16x16x32_bf16 v[136:139], v[104:107], v[20:23], v[136:139]
    s_nop 0
    v_add_f32_dpp v122, v122, v122 row_ror:2 row_mask:0xf bank_mask:0xf
    v_mfma_f32_16x16x32_bf16 v[124:127], v[112:115], v[24:27], v[124:127]
    s_nop 0
    v_add_f32_dpp v122, v122, v122 row_ror:1 row_mask:0xf bank_mask:0xf
    v_rcp_f32 v122, v122
    v_mfma_f32_16x16x32_bf16 v[128:131], v[112:115], v[28:31], v[128:131]
    v_mul_f32 v146, v120, v122
    v_mfma_f32_16x16x32_bf16 v[132:135], v[112:115], v[32:35], v[132:135]
    v_mfma_f32_16x16x32_bf16 v[136:139], v[112:115], v[36:39], v[136:139]
L_p1done:
    s_nop 0
    v_mul_f32_dpp v140, v146, v124 row_newbcast:0 row_mask:0xf bank_mask:0xf
    s_nop 2
    v_mul_f32_dpp v141, v146, v128 row_newbcast:0 row_mask:0xf bank_mask:0xf
    s_nop 0
    v_mul_f32_dpp v142, v146, v132 row_newbcast:0 row_mask:0xf bank_mask:0xf
    v_mul_f32_dpp v143, v146, v136 row_newbcast:0 row_mask:0xf bank_mask:0xf
    v_fmac_f32_dpp v140, v146, v125 row_newbcast:1 row_mask:0xf bank_mask:0xf
    v_fmac_f32_dpp v141, v146, v129 row_newbcast:1 row_mask:0xf bank_mask:0xf
    v_fmac_f32_dpp v142, v146, v133 row_newbcast:1 row_mask:0xf bank_mask:0xf
    v_fmac_f32_dpp v143, v146, v137 row_newbcast:1 row_mask:0xf bank_mask:0xf
    v_fmac_f32_dpp v140, v146, v126 row_newbcast:2 row_mask:0xf bank_mask:0xf
    v_fmac_f32_dpp v141, v146, v130 row_newbcast:2 row_mask:0xf bank_mask:0xf
    v_fmac_f32_dpp v142, v146, v134 row_newbcast:2 row_mask:0xf bank_mask:0xf
    v_fmac_f32_dpp v143, v146, v138 row_newbcast:2 row_mask:0xf bank_mask:0xf
    v_fmac_f32_dpp v140, v146, v127 row_newbcast:3 row_mask:0xf bank_mask:0xf
    v_fmac_f32_dpp v141, v146, v131 row_newbcast:3 row_mask:0xf bank_mask:0xf
    v_fmac_f32_dpp v142, v146, v135 row_newbcast:3 row_mask:0xf bank_mask:0xf
    v_fmac_f32_dpp v143, v146, v139 row_newbcast:3 row_mask:0xf bank_mask:0xf
    v_permlane16_swap_b32 v140, v141
    s_nop 0
    v_permlane16_swap_b32 v142, v143
    v_add_f32 v144, v140, v141
    v_add_f32 v142, v142, v143
    s_nop 1
    v_permlane32_swap_b32 v144, v142
    v_add_u32 v144, 0x80, v144
    v_and_or_b32 v144, v144, s53, v158
    global_store_dwordx2 v161, v[144:145], s[26:27] sc1
    s_cmp_eq_u32 s58, 0
    s_cbranch_scc0 L_fin
    s_cmp_lg_u32 s46, 0
    s_cbranch_scc1 L_lwok
    s_mov_b32 s45, 262144
    v_mov_b32 v8, 16
L_lw:
    global_load_dword v9, v8, s[24:25] sc1
    s_waitcnt vmcnt(0)
    v_readfirstlane_b32 s46, v9
    s_nop 0
    s_cmp_lg_u32 s46, 0
    s_cbranch_scc1 L_lwok
    s_sub_u32 s45, s45, 1
    s_cbranch_scc0 L_lw
L_lwok:
    s_xor_b32 s57, s57, s46
    s_bitcmp1_b32 s57, 0
    s_cbranch_scc1 L_fin
    s_mov_b32 s45, 262144
    s_movk_i32 s47, 0xff
    global_load_dwordx4 v[8:11], v155, s[26:27] offset:0 sc1
    global_load_dwordx4 v[12:15], v155, s[26:27] offset:1024 sc1
    global_load_dwordx4 v[16:19], v155, s[26:27] offset:2048 sc1
    global_load_dwordx4 v[20:23], v155, s[26:27] offset:3072 sc1
    s_sleep 2
L_py:
    global_load_dwordx4 v[24:27], v155, s[26:27] offset:0 sc1
    global_load_dwordx4 v[28:31], v155, s[26:27] offset:1024 sc1
    global_load_dwordx4 v[32:35], v155, s[26:27] offset:2048 sc1
    global_load_dwordx4 v[36:39], v155, s[26:27] offset:3072 sc1
    s_waitcnt vmcnt(7)
    v_xor_b32 v96, v88, v8
    v_xor_b32 v97, v89, v9
    v_xor_b32 v98, v90, v10
    v_xor_b32 v99, v91, v11
    v_and_b32 v124, s53, v8
    v_and_b32 v125, s53, v9
    v_and_b32 v126, s53, v10
    v_and_b32 v127, s53, v11
    s_waitcnt vmcnt(6)
    v_bitop3_b32 v96, v88, v12, v96 bitop3:0xbe
    v_bitop3_b32 v97, v89, v13, v97 bitop3:0xbe
    v_bitop3_b32 v98, v90, v14, v98 bitop3:0xbe
    v_bitop3_b32 v99, v91, v15, v99 bitop3:0xbe
    v_and_b32 v128, s53, v12
    v_and_b32 v129, s53, v13
    v_and_b32 v130, s53, v14
    v_and_b32 v131, s53, v15
    v_add_f32 v124, v124, v128
    v_add_f32 v125, v125, v129
    v_add_f32 v126, v126, v130
    v_add_f32 v127, v127, v131
    s_waitcnt vmcnt(5)
    v_bitop3_b32 v96, v88, v16, v96 bitop3:0xbe
    v_bitop3_b32 v97, v89, v17, v97 bitop3:0xbe
    v_bitop3_b32 v98, v90, v18, v98 bitop3:0xbe
    v_bitop3_b32 v99, v91, v19, v99 bitop3:0xbe
    v_and_b32 v128, s53, v16
    v_and_b32 v129, s53, v17
    v_and_b32 v130, s53, v18
    v_and_b32 v131, s53, v19
    v_add_f32 v124, v124, v128
    v_add_f32 v125, v125, v129
    v_add_f32 v126, v126, v130
    v_add_f32 v127, v127, v131
    s_waitcnt vmcnt(4)
    v_bitop3_b32 v96, v88, v20, v96 bitop3:0xbe
    v_bitop3_b32 v97, v89, v21, v97 bitop3:0xbe
    v_bitop3_b32 v98, v90, v22, v98 bitop3:0xbe
    v_bitop3_b32 v99, v91, v23, v99 bitop3:0xbe
    v_or3_b32 v96, v96, v97, v98
    v_bitop3_b32 v96, v96, v99, s47 bitop3:0xa8
    v_and_b32 v128, s53, v20
    v_and_b32 v129, s53, v21
    v_and_b32 v130, s53, v22
    v_and_b32 v131, s53, v23
    v_cmp_ne_u32 vcc, 0, v96
    v_add_f32 v124, v124, v128
    v_add_f32 v125, v125, v129
    v_add_f32 v126, v126, v130
    v_add_f32 v127, v127, v131
    s_cbranch_vccz L_pyfin
    global_load_dwordx4 v[8:11], v155, s[26:27] offset:0 sc1
    global_load_dwordx4 v[12:15], v155, s[26:27] offset:1024 sc1
    global_load_dwordx4 v[16:19], v155, s[26:27] offset:2048 sc1
    global_load_dwordx4 v[20:23], v155, s[26:27] offset:3072 sc1
    s_waitcnt vmcnt(7)
    v_xor_b32 v96, v88, v24
    v_xor_b32 v97, v89, v25
    v_xor_b32 v98, v90, v26
    v_xor_b32 v99, v91, v27
    v_and_b32 v124, s53, v24
    v_and_b32 v125, s53, v25
    v_and_b32 v126, s53, v26
    v_and_b32 v127, s53, v27
    s_waitcnt vmcnt(6)
    v_bitop3_b32 v96, v88, v28, v96 bitop3:0xbe
    v_bitop3_b32 v97, v89, v29, v97 bitop3:0xbe
    v_bitop3_b32 v98, v90, v30, v98 bitop3:0xbe
    v_bitop3_b32 v99, v91, v31, v99 bitop3:0xbe
    v_and_b32 v128, s53, v28
    v_and_b32 v129, s53, v29
    v_and_b32 v130, s53, v30
    v_and_b32 v131, s53, v31
    v_add_f32 v124, v124, v128
    v_add_f32 v125, v125, v129
    v_add_f32 v126, v126, v130
    v_add_f32 v127, v127, v131
    s_waitcnt vmcnt(5)
    v_bitop3_b32 v96, v88, v32, v96 bitop3:0xbe
    v_bitop3_b32 v97, v89, v33, v97 bitop3:0xbe
    v_bitop3_b32 v98, v90, v34, v98 bitop3:0xbe
    v_bitop3_b32 v99, v91, v35, v99 bitop3:0xbe
    v_and_b32 v128, s53, v32
    v_and_b32 v129, s53, v33
    v_and_b32 v130, s53, v34
    v_and_b32 v131, s53, v35
    v_add_f32 v124, v124, v128
    v_add_f32 v125, v125, v129
    v_add_f32 v126, v126, v130
    v_add_f32 v127, v127, v131
    s_waitcnt vmcnt(4)
    v_bitop3_b32 v96, v88, v36, v96 bitop3:0xbe
    v_bitop3_b32 v97, v89, v37, v97 bitop3:0xbe
    v_bitop3_b32 v98, v90, v38, v98 bitop3:0xbe
    v_bitop3_b32 v99, v91, v39, v99 bitop3:0xbe
    v_or3_b32 v96, v96, v97, v98
    v_bitop3_b32 v96, v96, v99, s47 bitop3:0xa8
    v_and_b32 v128, s53, v36
    v_and_b32 v129, s53, v37
    v_and_b32 v130, s53, v38
    v_and_b32 v131, s53, v39
    v_cmp_ne_u32 vcc, 0, v96
    v_add_f32 v124, v124, v128
    v_add_f32 v125, v125, v129
    v_add_f32 v126, v126, v130
    v_add_f32 v127, v127, v131
    s_cbranch_vccz L_pyfin
    s_sub_u32 s45, s45, 1
    s_cbranch_scc0 L_py
L_pyfin:
    v_permlane32_swap_b32 v124, v126
    v_permlane32_swap_b32 v125, v127
    v_add_f32 v124, v124, v126
    v_add_f32 v125, v125, v127
    s_nop 1
    v_permlane16_swap_b32 v124, v125
    v_add_f32 v124, v124, v125
    s_nop 1
    v_add_f32_dpp v124, v124, v124 row_ror:8 row_mask:0xf bank_mask:0xf
    v_mov_b32 v125, v124
    s_nop 1
    v_permlane16_swap_b32 v124, v125
    v_cvt_pk_bf16_f32 v124, v124, v125
    v_lshlrev_b32 v125, 16, v124
    v_and_b32 v126, s48, v124
    v_add_f32 v125, v154, v125
    v_cvt_pk_bf16_f32 v125, v125, v125
    v_and_b32 v125, s48, v125
    v_add_f32 v125, v125, v126
    v_cvt_pk_bf16_f32 v125, v125, v125
    s_mov_b32 exec_lo, 0xff
    s_mov_b32 exec_hi, 0xff
    global_store_short v156, v125, s[22:23]
    s_mov_b64 exec, -1
L_fin:
L_end:
    s_endpgm
L_att:
L_noy:
    s_memrealtime s[54:55]
    s_add_u32 s36, s8, s40
    s_addc_u32 s37, s9, 0
    s_and_b32 s37, s37, 0xffff
    s_mov_b32 s38, 0x20000
    s_mov_b32 s39, 0x20000
    s_cmp_lg_u32 s30, 8
    s_cbranch_scc1 L_noat
    s_cmp_ge_u32 s2, 8
    s_cbranch_scc1 L_noat
    s_getreg_b32 s31, hwreg(HW_REG_XCC_ID, 0, 4)
    s_and_b32 s31, s31, 7
    s_lshl_b32 s31, s31, 1
    s_or_b32 s31, s31, 1
    s_lshl_b32 s44, s2, 5
    v_mov_b32 v164, s44
    s_waitcnt lgkmcnt(0)
    s_lshl_b32 s53, s54, 4
    s_or_b32 s31, s31, s53
    v_mov_b32 v166, s31
    s_mov_b64 exec, 1
    global_store_dword v164, v166, s[24:25] sc1
    s_mov_b64 exec, -1
L_noat:
    v_mov_b32 v140, 0
    v_mov_b32 v141, 0
    v_mov_b32 v142, 0
    v_mov_b32 v143, 0
    v_mov_b32 v144, 0
    v_mov_b32 v145, 0
    v_mov_b32 v146, 0
    v_mov_b32 v147, 0
    v_mov_b32 v148, 0
    v_mov_b32 v149, 0
    v_mov_b32 v150, 0
    v_mov_b32 v151, 0
    v_mov_b32 v152, 0
    v_mov_b32 v153, 0
    v_mov_b32 v154, 0
    v_mov_b32 v155, 0
    v_mov_b32 v156, 0
    v_mov_b32 v157, 0
    v_mov_b32 v158, 0
    v_mov_b32 v159, 0
    v_mov_b32 v160, 0
    v_mov_b32 v161, 0
    v_mov_b32 v162, 0
    v_mov_b32 v163, 0
    v_mov_b32 v3, 29120
    v_and_b32 v6, 15, v0
    v_lshrrev_b32 v5, 4, v0
    v_lshl_add_u32 v4, v6, 2, v5
    v_lshlrev_b32 v4, 3, v4
    s_lshl_b32 s44, s43, 9
    v_add_u32 v4, s44, v4
    s_lshl_b32 s44, s43, 3
    v_mov_b32 v5, s44
    v_lshlrev_b32 v6, 4, v6
    v_mov_b32 v7, 1
    s_mov_b32 s47, 0x3db504f3
    s_mov_b32 s48, 0xffff0000
    s_mov_b32 s49, 0x3fb8aa3b
    s_barrier
    s_waitcnt vmcnt(2)
    s_xor_b32 s41, s42, 24576
    s_waitcnt vmcnt(2)
    buffer_load_dwordx4 v[20:23], v1, s[32:35], s41 offen nt
    s_xor_b32 s41, s42, 32768
    s_waitcnt vmcnt(2)
    buffer_load_dwordx4 v[24:27], v1, s[32:35], s41 offen nt
    s_xor_b32 s41, s42, 40960
    s_waitcnt vmcnt(2)
    buffer_load_dwordx4 v[28:31], v1, s[32:35], s41 offen nt
    s_xor_b32 s41, s42, 49152
    s_waitcnt vmcnt(2)
    buffer_load_dwordx4 v[32:35], v1, s[32:35], s41 offen nt
    s_xor_b32 s41, s42, 57344
    s_waitcnt vmcnt(2)
    buffer_load_dwordx4 v[36:39], v1, s[32:35], s41 offen nt
    s_xor_b32 s41, s42, 65536
    s_waitcnt vmcnt(2)
    buffer_load_dwordx4 v[40:43], v1, s[32:35], s41 offen nt
    s_xor_b32 s41, s42, 73728
    s_waitcnt vmcnt(2)
    buffer_load_dwordx4 v[44:47], v1, s[32:35], s41 offen nt
    s_xor_b32 s41, s42, 81920
    s_waitcnt vmcnt(2)
    buffer_load_dwordx4 v[48:51], v1, s[32:35], s41 offen nt
    s_xor_b32 s41, s42, 90112
    s_waitcnt vmcnt(2)
    buffer_load_dwordx4 v[52:55], v1, s[32:35], s41 offen nt
    s_memrealtime s[50:51]
    s_xor_b32 s41, s42, 98304
    s_waitcnt lgkmcnt(0)
    s_sub_u32 s52, s50, s54
    s_cmpk_gt_u32 s52, 416
    s_cbranch_scc1 L_deep12
    s_waitcnt vmcnt(2)
L_deep12:
    buffer_load_dwordx4 v[56:59], v1, s[32:35], s41 offen nt
    s_memrealtime s[50:51]
    s_cmp_lg_u32 s30, 5
    s_cbranch_scc1 L_nosig8
    ds_write_b32 v3, v7 offset:8
L_nosig8:
    s_xor_b32 s41, s42, 106496
    s_waitcnt lgkmcnt(0)
    s_sub_u32 s52, s50, s54
    s_cmpk_gt_u32 s52, 447
    s_cbranch_scc1 L_deep13
    s_waitcnt vmcnt(2)
L_deep13:
    buffer_load_dwordx4 v[60:63], v1, s[32:35], s41 offen nt
    s_memrealtime s[50:51]
    s_xor_b32 s41, s42, 114688
    s_waitcnt lgkmcnt(0)
    s_sub_u32 s52, s50, s54
    s_cmpk_gt_u32 s52, 477
    s_cbranch_scc1 L_deep14
    s_waitcnt vmcnt(2)
L_deep14:
    s_waitcnt vmcnt(4)
    buffer_load_dwordx4 v[64:67], v1, s[32:35], s41 offen nt
    s_memrealtime s[50:51]
    s_xor_b32 s41, s42, 122880
    s_waitcnt lgkmcnt(0)
    s_sub_u32 s52, s50, s54
    s_cmpk_gt_u32 s52, 508
    s_cbranch_scc1 L_deep15
    s_waitcnt vmcnt(2)
L_deep15:
    s_waitcnt vmcnt(4)
    buffer_load_dwordx4 v[68:71], v1, s[32:35], s41 offen nt
    s_memrealtime s[50:51]
    s_waitcnt lgkmcnt(0)
    s_sub_u32 s52, s50, s54
    s_cmpk_gt_u32 s52, 538
    s_cbranch_scc1 L_deep16
    s_waitcnt vmcnt(2)
L_deep16:
    s_waitcnt vmcnt(4)
    buffer_load_dwordx4 v[72:75], v1, s[36:39], s42 offen nt
    s_memrealtime s[50:51]
    s_xor_b32 s41, s42, 8192
    s_waitcnt lgkmcnt(0)
    s_sub_u32 s52, s50, s54
    s_cmpk_gt_u32 s52, 569
    s_cbranch_scc1 L_deep17
    s_waitcnt vmcnt(2)
L_deep17:
    s_waitcnt vmcnt(4)
    buffer_load_dwordx4 v[76:79], v1, s[36:39], s41 offen nt
    s_memrealtime s[50:51]
    s_xor_b32 s41, s42, 16384
    s_waitcnt lgkmcnt(0)
    s_sub_u32 s52, s50, s54
    s_cmpk_gt_u32 s52, 594
    s_cbranch_scc1 L_deep18
    s_waitcnt vmcnt(2)
L_deep18:
    s_waitcnt vmcnt(4)
    buffer_load_dwordx4 v[80:83], v1, s[36:39], s41 offen nt
    s_memrealtime s[50:51]
    s_xor_b32 s41, s42, 24576
    s_waitcnt lgkmcnt(0)
    s_sub_u32 s52, s50, s54
    s_cmpk_gt_u32 s52, 620
    s_cbranch_scc1 L_deep19
    s_waitcnt vmcnt(2)
L_deep19:
    s_waitcnt vmcnt(4)
    buffer_load_dwordx4 v[84:87], v1, s[36:39], s41 offen nt
    s_memrealtime s[50:51]
    s_xor_b32 s41, s42, 32768
    s_waitcnt lgkmcnt(0)
    s_sub_u32 s52, s50, s54
    s_cmpk_gt_u32 s52, 647
    s_cbranch_scc1 L_deep20
    s_waitcnt vmcnt(2)
L_deep20:
    s_waitcnt vmcnt(4)
    buffer_load_dwordx4 v[88:91], v1, s[36:39], s41 offen nt
    s_memrealtime s[50:51]
    s_xor_b32 s41, s42, 40960
    s_waitcnt lgkmcnt(0)
    s_sub_u32 s52, s50, s54
    s_cmpk_gt_u32 s52, 673
    s_cbranch_scc1 L_deep21
    s_waitcnt vmcnt(2)
L_deep21:
    s_waitcnt vmcnt(4)
    buffer_load_dwordx4 v[92:95], v1, s[36:39], s41 offen nt
    s_memrealtime s[50:51]
    s_xor_b32 s41, s42, 49152
    s_waitcnt lgkmcnt(0)
    s_sub_u32 s52, s50, s54
    s_cmpk_gt_u32 s52, 698
    s_cbranch_scc1 L_deep22
    s_waitcnt vmcnt(2)
L_deep22:
    s_waitcnt vmcnt(4)
    buffer_load_dwordx4 v[96:99], v1, s[36:39], s41 offen nt
    s_memrealtime s[50:51]
    s_xor_b32 s41, s42, 57344
    s_waitcnt lgkmcnt(0)
    s_sub_u32 s52, s50, s54
    s_cmpk_gt_u32 s52, 725
    s_cbranch_scc1 L_deep23
    s_waitcnt vmcnt(2)
L_deep23:
    s_waitcnt vmcnt(4)
    buffer_load_dwordx4 v[100:103], v1, s[36:39], s41 offen nt
    s_memrealtime s[50:51]
    s_mov_b32 s45, 2097152
L_qwait:
    ds_read_b32 v2, v3
    s_waitcnt lgkmcnt(0)
    v_readfirstlane_b32 s46, v2
    s_nop 0
    s_cmp_lg_u32 s46, 0
    s_cbranch_scc1 L_qok
    s_sleep 1
    s_sub_u32 s45, s45, 1
    s_cbranch_scc0 L_qwait
L_qok:
    ds_read_b128 v[136:139], v6 offset:28736
    s_waitcnt lgkmcnt(0)
    v_dot2c_f32_bf16 v140, v8, v136
    v_dot2c_f32_bf16 v141, v12, v136
    v_dot2c_f32_bf16 v142, v16, v136
    v_dot2c_f32_bf16 v143, v20, v136
    v_dot2c_f32_bf16 v140, v9, v137
    v_dot2c_f32_bf16 v141, v13, v137
    v_dot2c_f32_bf16 v142, v17, v137
    v_dot2c_f32_bf16 v143, v21, v137
    v_dot2c_f32_bf16 v140, v10, v138
    v_dot2c_f32_bf16 v141, v14, v138
    v_dot2c_f32_bf16 v142, v18, v138
    v_dot2c_f32_bf16 v143, v22, v138
    v_dot2c_f32_bf16 v140, v11, v139
    v_dot2c_f32_bf16 v141, v15, v139
    v_dot2c_f32_bf16 v142, v19, v139
    v_dot2c_f32_bf16 v143, v23, v139
    v_dot2c_f32_bf16 v144, v24, v136
    v_dot2c_f32_bf16 v145, v28, v136
    v_dot2c_f32_bf16 v146, v32, v136
    v_dot2c_f32_bf16 v147, v36, v136
    v_dot2c_f32_bf16 v144, v25, v137
    v_dot2c_f32_bf16 v145, v29, v137
    v_dot2c_f32_bf16 v146, v33, v137
    v_dot2c_f32_bf16 v147, v37, v137
    v_dot2c_f32_bf16 v144, v26, v138
    v_dot2c_f32_bf16 v145, v30, v138
    v_dot2c_f32_bf16 v146, v34, v138
    v_dot2c_f32_bf16 v147, v38, v138
    v_dot2c_f32_bf16 v144, v27, v139
    v_dot2c_f32_bf16 v145, v31, v139
    v_dot2c_f32_bf16 v146, v35, v139
    v_dot2c_f32_bf16 v147, v39, v139
    v_dot2c_f32_bf16 v148, v40, v136
    v_dot2c_f32_bf16 v149, v44, v136
    v_dot2c_f32_bf16 v150, v48, v136
    v_dot2c_f32_bf16 v151, v52, v136
    v_dot2c_f32_bf16 v148, v41, v137
    v_dot2c_f32_bf16 v149, v45, v137
    v_dot2c_f32_bf16 v150, v49, v137
    v_dot2c_f32_bf16 v151, v53, v137
    v_dot2c_f32_bf16 v148, v42, v138
    v_dot2c_f32_bf16 v149, v46, v138
    v_dot2c_f32_bf16 v150, v50, v138
    v_dot2c_f32_bf16 v151, v54, v138
    v_dot2c_f32_bf16 v148, v43, v139
    v_dot2c_f32_bf16 v149, v47, v139
    v_dot2c_f32_bf16 v150, v51, v139
    v_dot2c_f32_bf16 v151, v55, v139
    v_dot2c_f32_bf16 v152, v56, v136
    v_dot2c_f32_bf16 v153, v60, v136
    v_dot2c_f32_bf16 v154, v64, v136
    v_dot2c_f32_bf16 v155, v68, v136
    v_dot2c_f32_bf16 v152, v57, v137
    v_dot2c_f32_bf16 v153, v61, v137
    v_dot2c_f32_bf16 v154, v65, v137
    v_dot2c_f32_bf16 v155, v69, v137
    v_dot2c_f32_bf16 v152, v58, v138
    v_dot2c_f32_bf16 v153, v62, v138
    v_dot2c_f32_bf16 v154, v66, v138
    v_dot2c_f32_bf16 v155, v70, v138
    v_dot2c_f32_bf16 v152, v59, v139
    v_dot2c_f32_bf16 v153, v63, v139
    v_dot2c_f32_bf16 v154, v67, v139
    v_dot2c_f32_bf16 v155, v71, v139
    s_xor_b32 s41, s42, 65536
    s_waitcnt lgkmcnt(0)
    s_sub_u32 s52, s50, s54
    s_cmpk_gt_u32 s52, 751
    s_cbranch_scc1 L_deep24
    s_waitcnt vmcnt(2)
L_deep24:
    s_waitcnt vmcnt(4)
    buffer_load_dwordx4 v[104:107], v1, s[36:39], s41 offen nt
    s_memrealtime s[50:51]
    v_add_f32_dpp v140, v140, v140 row_ror:8 row_mask:0xf bank_mask:0x3
    v_add_f32_dpp v141, v141, v141 row_ror:8 row_mask:0xf bank_mask:0x3
    v_add_f32_dpp v142, v142, v142 row_ror:8 row_mask:0xf bank_mask:0x3
    v_add_f32_dpp v143, v143, v143 row_ror:8 row_mask:0xf bank_mask:0x3
    v_add_f32_dpp v144, v144, v144 row_ror:8 row_mask:0xf bank_mask:0x3
    v_add_f32_dpp v145, v145, v145 row_ror:8 row_mask:0xf bank_mask:0x3
    v_add_f32_dpp v146, v146, v146 row_ror:8 row_mask:0xf bank_mask:0x3
    v_add_f32_dpp v147, v147, v147 row_ror:8 row_mask:0xf bank_mask:0x3
    v_add_f32_dpp v140, v148, v148 row_ror:8 row_mask:0xf bank_mask:0xc
    v_add_f32_dpp v141, v149, v149 row_ror:8 row_mask:0xf bank_mask:0xc
    v_add_f32_dpp v142, v150, v150 row_ror:8 row_mask:0xf bank_mask:0xc
    v_add_f32_dpp v143, v151, v151 row_ror:8 row_mask:0xf bank_mask:0xc
    v_add_f32_dpp v144, v152, v152 row_ror:8 row_mask:0xf bank_mask:0xc
    v_add_f32_dpp v145, v153, v153 row_ror:8 row_mask:0xf bank_mask:0xc
    v_add_f32_dpp v146, v154, v154 row_ror:8 row_mask:0xf bank_mask:0xc
    v_add_f32_dpp v147, v155, v155 row_ror:8 row_mask:0xf bank_mask:0xc
    v_add_f32_dpp v140, v140, v140 row_half_mirror row_mask:0xf bank_mask:0x5
    v_add_f32_dpp v141, v141, v141 row_half_mirror row_mask:0xf bank_mask:0x5
    v_add_f32_dpp v142, v142, v142 row_half_mirror row_mask:0xf bank_mask:0x5
    v_add_f32_dpp v143, v143, v143 row_half_mirror row_mask:0xf bank_mask:0x5
    v_add_f32_dpp v140, v144, v144 row_half_mirror row_mask:0xf bank_mask:0xa
    v_add_f32_dpp v141, v145, v145 row_half_mirror row_mask:0xf bank_mask:0xa
    v_add_f32_dpp v142, v146, v146 row_half_mirror row_mask:0xf bank_mask:0xa
    v_add_f32_dpp v143, v147, v147 row_half_mirror row_mask:0xf bank_mask:0xa
    v_add_f32_dpp v140, v140, v140 quad_perm:[1,0,3,2] row_mask:0xf bank_mask:0xf
    v_add_f32_dpp v141, v141, v141 quad_perm:[1,0,3,2] row_mask:0xf bank_mask:0xf
    v_add_f32_dpp v142, v142, v142 quad_perm:[1,0,3,2] row_mask:0xf bank_mask:0xf
    v_add_f32_dpp v143, v143, v143 quad_perm:[1,0,3,2] row_mask:0xf bank_mask:0xf
    v_add_f32_dpp v140, v140, v140 quad_perm:[2,3,0,1] row_mask:0xf bank_mask:0xf
    v_add_f32_dpp v141, v141, v141 quad_perm:[2,3,0,1] row_mask:0xf bank_mask:0xf
    v_add_f32_dpp v142, v142, v142 quad_perm:[2,3,0,1] row_mask:0xf bank_mask:0xf
    v_add_f32_dpp v143, v143, v143 quad_perm:[2,3,0,1] row_mask:0xf bank_mask:0xf
    v_cvt_pk_bf16_f32 v144, v140, v141
    v_cvt_pk_bf16_f32 v145, v142, v143
    v_lshlrev_b32 v140, 16, v144
    v_and_b32 v141, s48, v144
    v_lshlrev_b32 v142, 16, v145
    v_and_b32 v143, s48, v145
    v_mul_f32 v140, s47, v140
    v_mul_f32 v141, s47, v141
    v_mul_f32 v142, s47, v142
    v_mul_f32 v143, s47, v143
    v_cvt_pk_bf16_f32 v144, v140, v141
    v_cvt_pk_bf16_f32 v145, v142, v143
    v_lshlrev_b32 v140, 16, v144
    v_and_b32 v141, s48, v144
    v_lshlrev_b32 v142, 16, v145
    v_and_b32 v143, s48, v145
    v_max3_f32 v146, v140, v141, v142
    v_max_f32 v146, v146, v143
    s_nop 1
    v_max_f32_dpp v146, v146, v146 row_ror:4 row_mask:0xf bank_mask:0xf
    s_nop 1
    v_max_f32_dpp v146, v146, v146 row_ror:8 row_mask:0xf bank_mask:0xf
    v_mov_b32 v145, v146
    s_nop 1
    v_permlane16_swap_b32 v146, v145
    v_max_f32 v146, v146, v145
    v_mov_b32 v145, v146
    s_nop 1
    v_permlane32_swap_b32 v146, v145
    v_max_f32 v146, v146, v145
    v_sub_f32 v140, v140, v146
    v_sub_f32 v141, v141, v146
    v_sub_f32 v142, v142, v146
    v_sub_f32 v143, v143, v146
    v_mul_f32 v140, s49, v140
    v_mul_f32 v141, s49, v141
    v_mul_f32 v142, s49, v142
    v_mul_f32 v143, s49, v143
    v_exp_f32 v140, v140
    v_exp_f32 v141, v141
    v_exp_f32 v142, v142
    v_exp_f32 v143, v143
    v_cvt_pk_bf16_f32 v148, v140, 0
    v_cvt_pk_bf16_f32 v149, v141, 0
    v_cvt_pk_bf16_f32 v150, v142, 0
    v_cvt_pk_bf16_f32 v151, v143, 0
    v_lshlrev_b32 v152, 16, v148
    v_lshlrev_b32 v153, 16, v149
    v_lshlrev_b32 v154, 16, v150
    v_lshlrev_b32 v155, 16, v151
    s_xor_b32 s41, s42, 73728
    s_waitcnt lgkmcnt(0)
    s_sub_u32 s52, s50, s54
    s_cmpk_gt_u32 s52, 777
    s_cbranch_scc1 L_deep25
    s_waitcnt vmcnt(2)
L_deep25:
    s_waitcnt vmcnt(4)
    buffer_load_dwordx4 v[108:111], v1, s[36:39], s41 offen nt
    s_memrealtime s[50:51]
    v_add_f32 v144, v140, v141
    v_add_f32 v145, v142, v143
    v_add_f32 v144, v144, v145
    s_nop 1
    v_add_f32_dpp v144, v144, v144 row_ror:4 row_mask:0xf bank_mask:0xf
    s_nop 1
    v_add_f32_dpp v144, v144, v144 row_ror:8 row_mask:0xf bank_mask:0xf
    v_mov_b32 v145, v144
    s_nop 1
    v_permlane16_swap_b32 v144, v145
    v_add_f32 v144, v144, v145
    v_mov_b32 v145, v144
    s_nop 1
    v_permlane32_swap_b32 v144, v145
    v_add_f32 v147, v144, v145
    ds_write_b64 v5, v[146:147] offset:28672
    s_mov_b64 exec, 1
    ds_add_u32 v3, v7 offset:12
    s_mov_b64 exec, -1
    v_dot2c_f32_bf16_dpp v156, v148, v72 row_newbcast:0 row_mask:0xf bank_mask:0xf
    v_dot2c_f32_bf16_dpp v157, v152, v72 row_newbcast:0 row_mask:0xf bank_mask:0xf
    v_dot2c_f32_bf16_dpp v158, v148, v73 row_newbcast:0 row_mask:0xf bank_mask:0xf
    v_dot2c_f32_bf16_dpp v159, v152, v73 row_newbcast:0 row_mask:0xf bank_mask:0xf
    v_dot2c_f32_bf16_dpp v160, v148, v74 row_newbcast:0 row_mask:0xf bank_mask:0xf
    v_dot2c_f32_bf16_dpp v161, v152, v74 row_newbcast:0 row_mask:0xf bank_mask:0xf
    v_dot2c_f32_bf16_dpp v162, v148, v75 row_newbcast:0 row_mask:0xf bank_mask:0xf
    v_dot2c_f32_bf16_dpp v163, v152, v75 row_newbcast:0 row_mask:0xf bank_mask:0xf
    v_dot2c_f32_bf16_dpp v156, v149, v76 row_newbcast:0 row_mask:0xf bank_mask:0xf
    v_dot2c_f32_bf16_dpp v157, v153, v76 row_newbcast:0 row_mask:0xf bank_mask:0xf
    v_dot2c_f32_bf16_dpp v158, v149, v77 row_newbcast:0 row_mask:0xf bank_mask:0xf
    v_dot2c_f32_bf16_dpp v159, v153, v77 row_newbcast:0 row_mask:0xf bank_mask:0xf
    v_dot2c_f32_bf16_dpp v160, v149, v78 row_newbcast:0 row_mask:0xf bank_mask:0xf
    v_dot2c_f32_bf16_dpp v161, v153, v78 row_newbcast:0 row_mask:0xf bank_mask:0xf
    v_dot2c_f32_bf16_dpp v162, v149, v79 row_newbcast:0 row_mask:0xf bank_mask:0xf
    v_dot2c_f32_bf16_dpp v163, v153, v79 row_newbcast:0 row_mask:0xf bank_mask:0xf
    v_dot2c_f32_bf16_dpp v156, v150, v80 row_newbcast:0 row_mask:0xf bank_mask:0xf
    v_dot2c_f32_bf16_dpp v157, v154, v80 row_newbcast:0 row_mask:0xf bank_mask:0xf
    v_dot2c_f32_bf16_dpp v158, v150, v81 row_newbcast:0 row_mask:0xf bank_mask:0xf
    v_dot2c_f32_bf16_dpp v159, v154, v81 row_newbcast:0 row_mask:0xf bank_mask:0xf
    v_dot2c_f32_bf16_dpp v160, v150, v82 row_newbcast:0 row_mask:0xf bank_mask:0xf
    v_dot2c_f32_bf16_dpp v161, v154, v82 row_newbcast:0 row_mask:0xf bank_mask:0xf
    v_dot2c_f32_bf16_dpp v162, v150, v83 row_newbcast:0 row_mask:0xf bank_mask:0xf
    v_dot2c_f32_bf16_dpp v163, v154, v83 row_newbcast:0 row_mask:0xf bank_mask:0xf
    v_dot2c_f32_bf16_dpp v156, v151, v84 row_newbcast:0 row_mask:0xf bank_mask:0xf
    v_dot2c_f32_bf16_dpp v157, v155, v84 row_newbcast:0 row_mask:0xf bank_mask:0xf
    v_dot2c_f32_bf16_dpp v158, v151, v85 row_newbcast:0 row_mask:0xf bank_mask:0xf
    v_dot2c_f32_bf16_dpp v159, v155, v85 row_newbcast:0 row_mask:0xf bank_mask:0xf
    v_dot2c_f32_bf16_dpp v160, v151, v86 row_newbcast:0 row_mask:0xf bank_mask:0xf
    v_dot2c_f32_bf16_dpp v161, v155, v86 row_newbcast:0 row_mask:0xf bank_mask:0xf
    v_dot2c_f32_bf16_dpp v162, v151, v87 row_newbcast:0 row_mask:0xf bank_mask:0xf
    v_dot2c_f32_bf16_dpp v163, v155, v87 row_newbcast:0 row_mask:0xf bank_mask:0xf
    v_dot2c_f32_bf16_dpp v156, v148, v88 row_newbcast:4 row_mask:0xf bank_mask:0xf
    v_dot2c_f32_bf16_dpp v157, v152, v88 row_newbcast:4 row_mask:0xf bank_mask:0xf
    v_dot2c_f32_bf16_dpp v158, v148, v89 row_newbcast:4 row_mask:0xf bank_mask:0xf
    v_dot2c_f32_bf16_dpp v159, v152, v89 row_newbcast:4 row_mask:0xf bank_mask:0xf
    v_dot2c_f32_bf16_dpp v160, v148, v90 row_newbcast:4 row_mask:0xf bank_mask:0xf
    v_dot2c_f32_bf16_dpp v161, v152, v90 row_newbcast:4 row_mask:0xf bank_mask:0xf
    v_dot2c_f32_bf16_dpp v162, v148, v91 row_newbcast:4 row_mask:0xf bank_mask:0xf
    v_dot2c_f32_bf16_dpp v163, v152, v91 row_newbcast:4 row_mask:0xf bank_mask:0xf
    s_xor_b32 s41, s42, 81920
    s_waitcnt lgkmcnt(0)
    s_sub_u32 s52, s50, s54
    s_cmpk_gt_u32 s52, 815
    s_cbranch_scc1 L_deep26
    s_waitcnt vmcnt(2)
L_deep26:
    s_waitcnt vmcnt(4)
    buffer_load_dwordx4 v[112:115], v1, s[36:39], s41 offen nt
    s_memrealtime s[50:51]
    v_dot2c_f32_bf16_dpp v156, v149, v92 row_newbcast:4 row_mask:0xf bank_mask:0xf
    v_dot2c_f32_bf16_dpp v157, v153, v92 row_newbcast:4 row_mask:0xf bank_mask:0xf
    v_dot2c_f32_bf16_dpp v158, v149, v93 row_newbcast:4 row_mask:0xf bank_mask:0xf
    v_dot2c_f32_bf16_dpp v159, v153, v93 row_newbcast:4 row_mask:0xf bank_mask:0xf
    v_dot2c_f32_bf16_dpp v160, v149, v94 row_newbcast:4 row_mask:0xf bank_mask:0xf
    v_dot2c_f32_bf16_dpp v161, v153, v94 row_newbcast:4 row_mask:0xf bank_mask:0xf
    v_dot2c_f32_bf16_dpp v162, v149, v95 row_newbcast:4 row_mask:0xf bank_mask:0xf
    v_dot2c_f32_bf16_dpp v163, v153, v95 row_newbcast:4 row_mask:0xf bank_mask:0xf
    s_xor_b32 s41, s42, 90112
    s_waitcnt lgkmcnt(0)
    s_sub_u32 s52, s50, s54
    s_cmpk_gt_u32 s52, 853
    s_cbranch_scc1 L_deep27
    s_waitcnt vmcnt(2)
L_deep27:
    s_waitcnt vmcnt(4)
    buffer_load_dwordx4 v[116:119], v1, s[36:39], s41 offen nt
    s_memrealtime s[50:51]
    v_dot2c_f32_bf16_dpp v156, v150, v96 row_newbcast:4 row_mask:0xf bank_mask:0xf
    v_dot2c_f32_bf16_dpp v157, v154, v96 row_newbcast:4 row_mask:0xf bank_mask:0xf
    v_dot2c_f32_bf16_dpp v158, v150, v97 row_newbcast:4 row_mask:0xf bank_mask:0xf
    v_dot2c_f32_bf16_dpp v159, v154, v97 row_newbcast:4 row_mask:0xf bank_mask:0xf
    v_dot2c_f32_bf16_dpp v160, v150, v98 row_newbcast:4 row_mask:0xf bank_mask:0xf
    v_dot2c_f32_bf16_dpp v161, v154, v98 row_newbcast:4 row_mask:0xf bank_mask:0xf
    v_dot2c_f32_bf16_dpp v162, v150, v99 row_newbcast:4 row_mask:0xf bank_mask:0xf
    v_dot2c_f32_bf16_dpp v163, v154, v99 row_newbcast:4 row_mask:0xf bank_mask:0xf
    s_xor_b32 s41, s42, 98304
    s_waitcnt lgkmcnt(0)
    s_sub_u32 s52, s50, s54
    s_cmpk_gt_u32 s52, 891
    s_cbranch_scc1 L_deep28
    s_waitcnt vmcnt(2)
L_deep28:
    s_waitcnt vmcnt(4)
    buffer_load_dwordx4 v[120:123], v1, s[36:39], s41 offen nt
    s_memrealtime s[50:51]
    v_dot2c_f32_bf16_dpp v156, v151, v100 row_newbcast:4 row_mask:0xf bank_mask:0xf
    v_dot2c_f32_bf16_dpp v157, v155, v100 row_newbcast:4 row_mask:0xf bank_mask:0xf
    v_dot2c_f32_bf16_dpp v158, v151, v101 row_newbcast:4 row_mask:0xf bank_mask:0xf
    v_dot2c_f32_bf16_dpp v159, v155, v101 row_newbcast:4 row_mask:0xf bank_mask:0xf
    v_dot2c_f32_bf16_dpp v160, v151, v102 row_newbcast:4 row_mask:0xf bank_mask:0xf
    v_dot2c_f32_bf16_dpp v161, v155, v102 row_newbcast:4 row_mask:0xf bank_mask:0xf
    v_dot2c_f32_bf16_dpp v162, v151, v103 row_newbcast:4 row_mask:0xf bank_mask:0xf
    v_dot2c_f32_bf16_dpp v163, v155, v103 row_newbcast:4 row_mask:0xf bank_mask:0xf
    s_xor_b32 s41, s42, 106496
    s_waitcnt lgkmcnt(0)
    s_sub_u32 s52, s50, s54
    s_cmpk_gt_u32 s52, 929
    s_cbranch_scc1 L_deep29
    s_waitcnt vmcnt(2)
L_deep29:
    s_waitcnt vmcnt(4)
    buffer_load_dwordx4 v[124:127], v1, s[36:39], s41 offen nt
    s_memrealtime s[50:51]
    v_dot2c_f32_bf16_dpp v156, v148, v104 row_newbcast:8 row_mask:0xf bank_mask:0xf
    v_dot2c_f32_bf16_dpp v157, v152, v104 row_newbcast:8 row_mask:0xf bank_mask:0xf
    v_dot2c_f32_bf16_dpp v158, v148, v105 row_newbcast:8 row_mask:0xf bank_mask:0xf
    v_dot2c_f32_bf16_dpp v159, v152, v105 row_newbcast:8 row_mask:0xf bank_mask:0xf
    v_dot2c_f32_bf16_dpp v160, v148, v106 row_newbcast:8 row_mask:0xf bank_mask:0xf
    v_dot2c_f32_bf16_dpp v161, v152, v106 row_newbcast:8 row_mask:0xf bank_mask:0xf
    v_dot2c_f32_bf16_dpp v162, v148, v107 row_newbcast:8 row_mask:0xf bank_mask:0xf
    v_dot2c_f32_bf16_dpp v163, v152, v107 row_newbcast:8 row_mask:0xf bank_mask:0xf
    s_xor_b32 s41, s42, 114688
    s_waitcnt lgkmcnt(0)
    s_sub_u32 s52, s50, s54
    s_cmpk_gt_u32 s52, 956
    s_cbranch_scc1 L_deep30
    s_waitcnt vmcnt(2)
L_deep30:
    s_waitcnt vmcnt(4)
    buffer_load_dwordx4 v[128:131], v1, s[36:39], s41 offen nt
    s_memrealtime s[50:51]
    v_dot2c_f32_bf16_dpp v156, v149, v108 row_newbcast:8 row_mask:0xf bank_mask:0xf
    v_dot2c_f32_bf16_dpp v157, v153, v108 row_newbcast:8 row_mask:0xf bank_mask:0xf
    v_dot2c_f32_bf16_dpp v158, v149, v109 row_newbcast:8 row_mask:0xf bank_mask:0xf
    v_dot2c_f32_bf16_dpp v159, v153, v109 row_newbcast:8 row_mask:0xf bank_mask:0xf
    v_dot2c_f32_bf16_dpp v160, v149, v110 row_newbcast:8 row_mask:0xf bank_mask:0xf
    v_dot2c_f32_bf16_dpp v161, v153, v110 row_newbcast:8 row_mask:0xf bank_mask:0xf
    v_dot2c_f32_bf16_dpp v162, v149, v111 row_newbcast:8 row_mask:0xf bank_mask:0xf
    v_dot2c_f32_bf16_dpp v163, v153, v111 row_newbcast:8 row_mask:0xf bank_mask:0xf
    s_xor_b32 s41, s42, 122880
    s_waitcnt lgkmcnt(0)
    s_sub_u32 s52, s50, s54
    s_cmpk_gt_u32 s52, 983
    s_cbranch_scc1 L_deep31
    s_waitcnt vmcnt(2)
L_deep31:
    s_waitcnt vmcnt(4)
    buffer_load_dwordx4 v[132:135], v1, s[36:39], s41 offen nt
    s_mov_b64 exec, 1
    ds_add_u32 v3, v7 offset:4
    s_mov_b64 exec, -1
    v_dot2c_f32_bf16_dpp v156, v150, v112 row_newbcast:8 row_mask:0xf bank_mask:0xf
    v_dot2c_f32_bf16_dpp v157, v154, v112 row_newbcast:8 row_mask:0xf bank_mask:0xf
    v_dot2c_f32_bf16_dpp v158, v150, v113 row_newbcast:8 row_mask:0xf bank_mask:0xf
    v_dot2c_f32_bf16_dpp v159, v154, v113 row_newbcast:8 row_mask:0xf bank_mask:0xf
    v_dot2c_f32_bf16_dpp v160, v150, v114 row_newbcast:8 row_mask:0xf bank_mask:0xf
    v_dot2c_f32_bf16_dpp v161, v154, v114 row_newbcast:8 row_mask:0xf bank_mask:0xf
    v_dot2c_f32_bf16_dpp v162, v150, v115 row_newbcast:8 row_mask:0xf bank_mask:0xf
    v_dot2c_f32_bf16_dpp v163, v154, v115 row_newbcast:8 row_mask:0xf bank_mask:0xf
    s_waitcnt vmcnt(4)
    v_dot2c_f32_bf16_dpp v156, v151, v116 row_newbcast:8 row_mask:0xf bank_mask:0xf
    v_dot2c_f32_bf16_dpp v157, v155, v116 row_newbcast:8 row_mask:0xf bank_mask:0xf
    v_dot2c_f32_bf16_dpp v158, v151, v117 row_newbcast:8 row_mask:0xf bank_mask:0xf
    v_dot2c_f32_bf16_dpp v159, v155, v117 row_newbcast:8 row_mask:0xf bank_mask:0xf
    v_dot2c_f32_bf16_dpp v160, v151, v118 row_newbcast:8 row_mask:0xf bank_mask:0xf
    v_dot2c_f32_bf16_dpp v161, v155, v118 row_newbcast:8 row_mask:0xf bank_mask:0xf
    v_dot2c_f32_bf16_dpp v162, v151, v119 row_newbcast:8 row_mask:0xf bank_mask:0xf
    v_dot2c_f32_bf16_dpp v163, v155, v119 row_newbcast:8 row_mask:0xf bank_mask:0xf
    s_waitcnt vmcnt(3)
    v_dot2c_f32_bf16_dpp v156, v148, v120 row_newbcast:12 row_mask:0xf bank_mask:0xf
    v_dot2c_f32_bf16_dpp v157, v152, v120 row_newbcast:12 row_mask:0xf bank_mask:0xf
    v_dot2c_f32_bf16_dpp v158, v148, v121 row_newbcast:12 row_mask:0xf bank_mask:0xf
    v_dot2c_f32_bf16_dpp v159, v152, v121 row_newbcast:12 row_mask:0xf bank_mask:0xf
    v_dot2c_f32_bf16_dpp v160, v148, v122 row_newbcast:12 row_mask:0xf bank_mask:0xf
    v_dot2c_f32_bf16_dpp v161, v152, v122 row_newbcast:12 row_mask:0xf bank_mask:0xf
    v_dot2c_f32_bf16_dpp v162, v148, v123 row_newbcast:12 row_mask:0xf bank_mask:0xf
    v_dot2c_f32_bf16_dpp v163, v152, v123 row_newbcast:12 row_mask:0xf bank_mask:0xf
    s_waitcnt vmcnt(2)
    v_dot2c_f32_bf16_dpp v156, v149, v124 row_newbcast:12 row_mask:0xf bank_mask:0xf
    v_dot2c_f32_bf16_dpp v157, v153, v124 row_newbcast:12 row_mask:0xf bank_mask:0xf
    v_dot2c_f32_bf16_dpp v158, v149, v125 row_newbcast:12 row_mask:0xf bank_mask:0xf
    v_dot2c_f32_bf16_dpp v159, v153, v125 row_newbcast:12 row_mask:0xf bank_mask:0xf
    v_dot2c_f32_bf16_dpp v160, v149, v126 row_newbcast:12 row_mask:0xf bank_mask:0xf
    v_dot2c_f32_bf16_dpp v161, v153, v126 row_newbcast:12 row_mask:0xf bank_mask:0xf
    v_dot2c_f32_bf16_dpp v162, v149, v127 row_newbcast:12 row_mask:0xf bank_mask:0xf
    v_dot2c_f32_bf16_dpp v163, v153, v127 row_newbcast:12 row_mask:0xf bank_mask:0xf
    s_waitcnt vmcnt(1)
    v_dot2c_f32_bf16_dpp v156, v150, v128 row_newbcast:12 row_mask:0xf bank_mask:0xf
    v_dot2c_f32_bf16_dpp v157, v154, v128 row_newbcast:12 row_mask:0xf bank_mask:0xf
    v_dot2c_f32_bf16_dpp v158, v150, v129 row_newbcast:12 row_mask:0xf bank_mask:0xf
    v_dot2c_f32_bf16_dpp v159, v154, v129 row_newbcast:12 row_mask:0xf bank_mask:0xf
    v_dot2c_f32_bf16_dpp v160, v150, v130 row_newbcast:12 row_mask:0xf bank_mask:0xf
    v_dot2c_f32_bf16_dpp v161, v154, v130 row_newbcast:12 row_mask:0xf bank_mask:0xf
    v_dot2c_f32_bf16_dpp v162, v150, v131 row_newbcast:12 row_mask:0xf bank_mask:0xf
    v_dot2c_f32_bf16_dpp v163, v154, v131 row_newbcast:12 row_mask:0xf bank_mask:0xf
    s_waitcnt vmcnt(0)
    v_dot2c_f32_bf16_dpp v156, v151, v132 row_newbcast:12 row_mask:0xf bank_mask:0xf
    v_dot2c_f32_bf16_dpp v157, v155, v132 row_newbcast:12 row_mask:0xf bank_mask:0xf
    v_dot2c_f32_bf16_dpp v158, v151, v133 row_newbcast:12 row_mask:0xf bank_mask:0xf
    v_dot2c_f32_bf16_dpp v159, v155, v133 row_newbcast:12 row_mask:0xf bank_mask:0xf
    v_dot2c_f32_bf16_dpp v160, v151, v134 row_newbcast:12 row_mask:0xf bank_mask:0xf
    v_dot2c_f32_bf16_dpp v161, v155, v134 row_newbcast:12 row_mask:0xf bank_mask:0xf
    v_dot2c_f32_bf16_dpp v162, v151, v135 row_newbcast:12 row_mask:0xf bank_mask:0xf
    v_dot2c_f32_bf16_dpp v163, v155, v135 row_newbcast:12 row_mask:0xf bank_mask:0xf
    v_permlane32_swap_b32 v156, v160
    v_permlane32_swap_b32 v157, v161
    v_permlane32_swap_b32 v158, v162
    v_permlane32_swap_b32 v159, v163
    v_add_f32 v156, v156, v160
    v_add_f32 v157, v157, v161
    v_add_f32 v158, v158, v162
    v_add_f32 v159, v159, v163
    s_nop 0
    v_permlane16_swap_b32 v156, v158
    v_permlane16_swap_b32 v157, v159
    v_add_f32 v156, v156, v158
    v_add_f32 v157, v157, v159
    ds_write_b64 v4, v[156:157] offset:24576
    s_waitcnt lgkmcnt(0)
    s_barrier
    s_endpgm
L_probe:
    s_cmp_lg_u32 s2, 0
    s_cbranch_scc1 L_end
    s_barrier
    s_waitcnt lgkmcnt(0)
    s_add_u32 s40, s26, 655360
    s_addc_u32 s41, s27, 0
    s_mov_b32 s48, -1
    s_mov_b32 s49, -1
    s_memtime s[44:45]
    s_waitcnt lgkmcnt(0)
    s_load_dword s46, s[40:41], 8192 glc
    s_waitcnt lgkmcnt(0)
    s_memtime s[46:47]
    s_waitcnt lgkmcnt(0)
    s_memtime s[44:45]
    s_waitcnt lgkmcnt(0)
    s_load_dword s46, s[40:41], 0 glc
    s_waitcnt lgkmcnt(0)
    s_memtime s[46:47]
    s_waitcnt lgkmcnt(0)
    s_memtime s[44:45]
    s_waitcnt lgkmcnt(0)
    s_load_dword s46, s[40:41], 256 glc
    s_waitcnt lgkmcnt(0)
    s_memtime s[46:47]
    s_waitcnt lgkmcnt(0)
    s_sub_u32 s46, s46, s44
    s_min_u32 s48, s48, s46
    s_memtime s[44:45]
    s_waitcnt lgkmcnt(0)
    s_load_dword s46, s[40:41], 8448 glc
    s_waitcnt lgkmcnt(0)
    s_memtime s[46:47]
    s_waitcnt lgkmcnt(0)
    s_sub_u32 s46, s46, s44
    s_min_u32 s49, s49, s46
    s_memtime s[44:45]
    s_waitcnt lgkmcnt(0)
    s_load_dword s46, s[40:41], 8704 glc
    s_waitcnt lgkmcnt(0)
    s_memtime s[46:47]
    s_waitcnt lgkmcnt(0)
    s_sub_u32 s46, s46, s44
    s_min_u32 s49, s49, s46
    s_memtime s[44:45]
    s_waitcnt lgkmcnt(0)
    s_load_dword s46, s[40:41], 512 glc
    s_waitcnt lgkmcnt(0)
    s_memtime s[46:47]
    s_waitcnt lgkmcnt(0)
    s_sub_u32 s46, s46, s44
    s_min_u32 s48, s48, s46
    s_memtime s[44:45]
    s_waitcnt lgkmcnt(0)
    s_load_dword s46, s[40:41], 768 glc
    s_waitcnt lgkmcnt(0)
    s_memtime s[46:47]
    s_waitcnt lgkmcnt(0)
    s_sub_u32 s46, s46, s44
    s_min_u32 s48, s48, s46
    s_memtime s[44:45]
    s_waitcnt lgkmcnt(0)
    s_load_dword s46, s[40:41], 8960 glc
    s_waitcnt lgkmcnt(0)
    s_memtime s[46:47]
    s_waitcnt lgkmcnt(0)
    s_sub_u32 s46, s46, s44
    s_min_u32 s49, s49, s46
    s_memtime s[44:45]
    s_waitcnt lgkmcnt(0)
    s_load_dword s46, s[40:41], 9216 glc
    s_waitcnt lgkmcnt(0)
    s_memtime s[46:47]
    s_waitcnt lgkmcnt(0)
    s_sub_u32 s46, s46, s44
    s_min_u32 s49, s49, s46
    s_memtime s[44:45]
    s_waitcnt lgkmcnt(0)
    s_load_dword s46, s[40:41], 1024 glc
    s_waitcnt lgkmcnt(0)
    s_memtime s[46:47]
    s_waitcnt lgkmcnt(0)
    s_sub_u32 s46, s46, s44
    s_min_u32 s48, s48, s46
    s_memtime s[44:45]
    s_waitcnt lgkmcnt(0)
    s_load_dword s46, s[40:41], 1280 glc
    s_waitcnt lgkmcnt(0)
    s_memtime s[46:47]
    s_waitcnt lgkmcnt(0)
    s_sub_u32 s46, s46, s44
    s_min_u32 s48, s48, s46
    s_memtime s[44:45]
    s_waitcnt lgkmcnt(0)
    s_load_dword s46, s[40:41], 9472 glc
    s_waitcnt lgkmcnt(0)
    s_memtime s[46:47]
    s_waitcnt lgkmcnt(0)
    s_sub_u32 s46, s46, s44
    s_min_u32 s49, s49, s46
    s_memtime s[44:45]
    s_waitcnt lgkmcnt(0)
    s_load_dword s46, s[40:41], 9728 glc
    s_waitcnt lgkmcnt(0)
    s_memtime s[46:47]
    s_waitcnt lgkmcnt(0)
    s_sub_u32 s46, s46, s44
    s_min_u32 s49, s49, s46
    s_memtime s[44:45]
    s_waitcnt lgkmcnt(0)
    s_load_dword s46, s[40:41], 1536 glc
    s_waitcnt lgkmcnt(0)
    s_memtime s[46:47]
    s_waitcnt lgkmcnt(0)
    s_sub_u32 s46, s46, s44
    s_min_u32 s48, s48, s46
    s_getreg_b32 s31, hwreg(HW_REG_XCC_ID, 2, 1)
    s_cmp_lt_u32 s49, s48
    s_cselect_b32 s44, 3, 2
    s_xor_b32 s44, s44, s31
    v_mov_b32 v1, 16
    v_mov_b32 v2, s44
    s_mov_b64 exec, 1
    global_store_dword v1, v2, s[24:25] sc1
    s_endpgm
L_codeend:

.section .rodata,"a"
.p2align 6
.amdhsa_kernel parallel_sum__sliding_block_cached__geglu_ffn__decode_kernel
  .amdhsa_next_free_vgpr 168
  .amdhsa_next_free_sgpr 96
  .amdhsa_accum_offset 168
  .amdhsa_group_segment_fixed_size 0
  .amdhsa_kernarg_size 96
  .amdhsa_user_sgpr_count 2
  .amdhsa_user_sgpr_kernarg_segment_ptr 1
  .amdhsa_system_sgpr_workgroup_id_x 1
.end_amdhsa_kernel
```
